```python
import torch

def _softmax(x, axis=-1):
    return torch.softmax(x, dim=axis)
def _gelu(x):
    return torch.nn.functional.gelu(x, approximate="tanh")
def _silu(x):
    return torch.nn.functional.silu(x)
def _sigmoid(x):
    return torch.sigmoid(x)
def _layernorm(x, axis=-1, eps=1e-5):
    m = x.mean(dim=axis, keepdim=True)
    v = x.var(dim=axis, keepdim=True, unbiased=False)
    return (x - m) / torch.sqrt(v + eps)
def _scatter_add(tgt, idx, src, axis=0):
    return tgt.clone().index_add_(axis, idx, src)
def _segment_sum(src, seg, n):
    out = torch.zeros((n,) + src.shape[1:], dtype=src.dtype)
    return out.index_add_(0, seg, src)
def _pad(x, pw):
    flat = tuple(v for pair in reversed(pw) for v in pair)
    return torch.nn.functional.pad(x, flat)

kernel_name = 'recurrent_scan__ssm_conv_s5__glu_gated_glu__prompt'

def setup_inputs():

    _w = (lambda a: (lambda t: t.to(torch.bfloat16) if t.is_floating_point() else t)(torch.as_tensor(a)))
    def _A_setup():
        B, S, D = 1, 2048, 448
        P = D
        Lambda_re = -0.5 * (lambda _x: torch.exp(torch.as_tensor(_x)))((lambda *s: torch.randn(*s, dtype=torch.bfloat16) * 0.2)(P))
        Lambda_im = (lambda *s: torch.randn(*s, dtype=torch.bfloat16) * 0.4)(P) * 1.0
        B_re = (lambda *s: torch.randn(*s, dtype=torch.bfloat16) * 0.2)(P, D) * (D ** -0.5)
        B_im = (lambda *s: torch.randn(*s, dtype=torch.bfloat16) * 0.2)(P, D) * (D ** -0.5)
        C_re = (lambda *s: torch.randn(*s, dtype=torch.bfloat16) * 0.2)(D, P) * (P ** -0.5)
        C_im = (lambda *s: torch.randn(*s, dtype=torch.bfloat16) * 0.2)(D, P) * (P ** -0.5)
        log_dt = (lambda *s: torch.randn(*s, dtype=torch.bfloat16) * 0.2)(P) * 0.3 - 2.0
        Dskip = (lambda *s: torch.randn(*s, dtype=torch.bfloat16) * 0.05)(D)
        return {
            "x": _w((lambda *s: torch.randn(*s, dtype=torch.bfloat16) * 0.05)(B, S, D)),
            "Lambda_re": _w(Lambda_re),
            "Lambda_im": _w(Lambda_im),
            "B_re": _w(B_re),
            "B_im": _w(B_im),
            "C_re": _w(C_re),
            "C_im": _w(C_im),
            "log_dt": _w(log_dt),
            "Dskip": _w(Dskip),
        }
    _A_in = _A_setup()

    def _B_setup():
        B, S, D, F = 1, 2048, 448, 1792
        return {
            "x": _w((lambda *s: torch.randn(*s, dtype=torch.bfloat16) * 0.05)(B, S, D)),
            "w_gate": _w((lambda *s: torch.randn(*s, dtype=torch.bfloat16) * 0.05)(D, F)),
            "w_up": _w((lambda *s: torch.randn(*s, dtype=torch.bfloat16) * 0.05)(D, F)),
            "w_down": _w((lambda *s: torch.randn(*s, dtype=torch.bfloat16) * 0.05)(F, D)),
        }
    _B_in = _B_setup()

    return {
        "A_x": _A_in["x"],
        "A_Lambda_re": _A_in["Lambda_re"],
        "A_Lambda_im": _A_in["Lambda_im"],
        "A_B_re": _A_in["B_re"],
        "A_B_im": _A_in["B_im"],
        "A_C_re": _A_in["C_re"],
        "A_C_im": _A_in["C_im"],
        "A_log_dt": _A_in["log_dt"],
        "A_Dskip": _A_in["Dskip"],
        "B_x": _B_in["x"],
        "B_w_gate": _B_in["w_gate"],
        "B_w_up": _B_in["w_up"],
        "B_w_down": _B_in["w_down"],
    }

def reference(A_x, A_Lambda_re, A_Lambda_im, A_B_re, A_B_im, A_C_re, A_C_im, A_log_dt, A_Dskip, B_x, B_w_gate, B_w_up, B_w_down):
    def _A_ref(x, Lambda_re, Lambda_im, B_re, B_im, C_re, C_im, log_dt, Dskip):
        Bsz, L, H = x.shape
        Lam = Lambda_re + 1j * Lambda_im
        Bmat = B_re + 1j * B_im
        Cmat = C_re + 1j * C_im
        dt = torch.exp(log_dt)
        Lam_bar = torch.exp(dt * Lam)
        B_bar = ((Lam_bar - 1.0) / Lam)[:, None] * Bmat
        Bu = torch.einsum("bld,pd->blp", x + 0j, B_bar)
        h = torch.zeros_like(Bu[:, 0, :])
        hs = []
        for t in range(L):
            h = Lam_bar[None, :] * h + Bu[:, t, :]
            hs.append(h)
        hseq = torch.stack(hs, 1)
        y = 2.0 * torch.einsum("blp,dp->bld", hseq, Cmat).real + x * Dskip[None, None, :]
        return y

    def _B_ref(x, w_gate, w_up, w_down):
        g = torch.einsum("bsd,df->bsf", x, w_gate)
        u = torch.einsum("bsd,df->bsf", x, w_up)
        h = _sigmoid(g) * u
        return torch.einsum("bsf,fd->bsd", h, w_down)

    x = A_x
    xn = _layernorm(x, axis=-1)
    s = _A_ref(xn, A_Lambda_re, A_Lambda_im, A_B_re, A_B_im, A_C_re, A_C_im, A_log_dt, A_Dskip)
    g = _silu(_B_ref(xn, B_w_gate, B_w_up, B_w_down))
    return x + s * g
```

```asm
; @launch grid=(256,1,1) block=(512,1,1) lds=163840
.amdgcn_target "amdgcn-amd-amdhsa--gfx950"
.text
.globl recurrent_scan__ssm_conv_s5__glu_gated_glu__prompt_kernel
.p2align 8
.type recurrent_scan__ssm_conv_s5__glu_gated_glu__prompt_kernel,@function
recurrent_scan__ssm_conv_s5__glu_gated_glu__prompt_kernel:
  s_cmp_ge_u32 s2, 256
  s_cbranch_scc1 K1_END
K1_CODE_FIRST:
  s_load_dwordx2 s[4:5], s[0:1], 0
  s_load_dwordx2 s[6:7], s[0:1], 8
  s_load_dwordx2 s[8:9], s[0:1], 24
  s_load_dwordx2 s[10:11], s[0:1], 32
  s_load_dwordx2 s[12:13], s[0:1], 80
  s_load_dwordx2 s[14:15], s[0:1], 88
  s_load_dwordx2 s[16:17], s[0:1], 112
  s_load_dwordx2 s[18:19], s[0:1], 120
  s_load_dwordx2 s[62:63], s[0:1], 16
  s_load_dwordx2 s[86:87], s[0:1], 96
  s_load_dwordx2 s[88:89], s[0:1], 40
  s_load_dwordx2 s[90:91], s[0:1], 48
  s_load_dwordx2 s[64:65], s[0:1], 56
  v_lshrrev_b32 v1, 6, v0
  v_and_b32 v0, 63, v0
  v_readfirstlane_b32 s48, v1
  s_sub_u32 s49, s2, 32
  s_and_b32 s50, s49, 7
  s_lshr_b32 s51, s49, 3
  s_mul_i32 s54, s51, 37
  s_lshr_b32 s54, s54, 8
  s_mul_i32 s53, s54, 7
  s_sub_u32 s55, s51, s53
  s_and_b32 s52, s50, 3
  s_lshl_b32 s53, s54, 2
  s_add_u32 s52, s52, s53
  s_lshl_b32 s51, s55, 2
  s_add_u32 s51, s51, s54
  s_lshr_b32 s53, s50, 2
  s_mul_i32 s53, s53, 7
  s_add_u32 s53, s53, s55
  s_and_b32 s54, s48, 3
  s_lshr_b32 s55, s48, 2
  v_lshrrev_b32 v40, 3, v0
  v_and_b32 v41, 7, v0
  v_lshrrev_b32 v42, 4, v0
  s_movk_i32 s56, 896
  s_lshl_b32 s57, s48, 4
  v_add_u32 v43, s57, v40
  v_mul_lo_u32 v43, s56, v43
  v_xor_b32 v44, v41, v42
  v_lshl_add_u32 v11, v44, 4, v43
  v_add_u32 v44, 4, v42
  v_xor_b32 v44, v41, v44
  v_lshl_add_u32 v12, v44, 4, v43
  v_add_u32 v12, 7168, v12
  s_lshl_b32 s57, s54, 3
  v_add_u32 v43, s57, v40
  v_mul_lo_u32 v43, s56, v43
  s_and_b32 s57, s48, 1
  s_lshl_b32 s57, s57, 2
  v_add_u32 v44, s57, v42
  v_xor_b32 v44, v41, v44
  v_lshl_add_u32 v13, v44, 4, v43
  s_lshl_b32 s57, s54, 3
  v_add_u32 v43, s57, v40
  s_movk_i32 s56, 3584
  v_mul_lo_u32 v43, s56, v43
  v_and_b32 v44, 1, v42
  s_lshl_b32 s57, s55, 1
  v_add_u32 v44, s57, v44
  v_lshlrev_b32 v44, 1, v44
  v_xor_b32 v44, v41, v44
  v_lshl_add_u32 v14, v44, 4, v43
  s_mul_i32 s66, s52, 114688
  s_mul_i32 s67, s53, 28672
  s_lshl_b32 s72, s53, 8
  s_lshl_b32 s73, s48, 11
  s_lshl_b32 s74, s48, 10
  s_add_u32 s74, s74, 49152
  s_lshl_b32 s75, s55, 13
  s_lshl_b32 s76, s54, 10
  s_add_u32 s75, s75, s76
  s_add_u32 s75, s75, 73728
  s_waitcnt lgkmcnt(0)
  s_cmp_lt_u32 s2, 32
  s_cbranch_scc1 K1_HELPER
  s_mov_b32 s20, s4
  s_and_b32 s21, s5, 0xffff
  s_mov_b32 s22, 1835008
  s_mov_b32 s23, 0x20000
  s_mov_b32 s77, 0
  s_mov_b32 s76, s77
  s_lshl_b32 s4, s76, 7
  s_add_u32 s4, s4, s66
  s_sub_u32 s67, s67, s66
  s_mov_b32 s68, s64
  s_and_b32 s69, s65, 0xffff
  s_mov_b32 s70, 896
  s_mov_b32 s71, 0x20000
  s_add_u32 m0, s73, 0
  s_nop 0
  buffer_load_dwordx4 v11, s[20:23], s4 offen lds
  s_add_u32 m0, s73, 1024
  s_nop 0
  buffer_load_dwordx4 v12, s[20:23], s4 offen lds
  s_cmp_eq_u32 s55, 0
  s_cselect_b32 s24, s8, s10
  s_cselect_b32 s25, s9, s11
  s_cselect_b32 s28, s12, s14
  s_cselect_b32 s29, s13, s15
  s_and_b32 s25, s25, 0xffff
  s_mov_b32 s26, 401408
  s_mov_b32 s27, 0x20000
  s_and_b32 s29, s29, 0xffff
  s_mov_b32 s30, 1605632
  s_mov_b32 s31, 0x20000
  s_add_u32 m0, s74, 0
  s_add_u32 s77, s67, s4
  buffer_load_dwordx4 v13, s[24:27], s77 offen lds
  s_mov_b32 s40, s6
  s_and_b32 s41, s7, 0xffff
  s_mov_b32 s42, 896
  s_mov_b32 s43, 0x20000
  s_mov_b32 s44, s62
  s_and_b32 s45, s63, 0xffff
  s_mov_b32 s46, 896
  s_mov_b32 s47, 0x20000
  s_mov_b32 s32, s18
  s_and_b32 s33, s19, 0xffff
  s_mov_b32 s34, 11195392
  s_mov_b32 s35, 0x20000
  s_mov_b32 s36, s16
  s_and_b32 s37, s17, 0xffff
  s_mov_b32 s38, 256
  s_mov_b32 s39, 0x20000
  s_mov_b32 s60, 0
  s_cmp_lt_u32 s48, 2
  s_cselect_b32 s61, 1, 0
  s_cmp_lt_u32 s53, 8
  s_cselect_b32 s60, s61, 0
  s_cmp_eq_u32 s48, 2
  s_cselect_b32 s61, 2, 0
  s_cmp_lt_u32 s52, 8
  s_cselect_b32 s61, s61, 0
  s_or_b32 s60, s60, s61
  s_lshl_b32 s56, s52, 7
  s_lshl_b32 s57, s53, 4
  s_add_u32 s56, s56, s57
  s_lshl_b32 s57, s48, 3
  s_add_u32 s56, s56, s57
  s_lshl_b32 s57, s53, 5
  s_and_b32 s58, s52, 3
  s_lshl_b32 s58, s58, 3
  s_add_u32 s57, s57, s58
  s_cmp_eq_u32 s60, 2
  s_cselect_b32 s59, s57, s56
  s_cmp_ge_u32 s52, 4
  s_cselect_b32 s92, s10, s8
  s_cselect_b32 s93, s11, s9
  s_cselect_b32 s62, 448, 0
  s_cmp_eq_u32 s60, 2
  s_cselect_b32 s92, s92, s20
  s_cselect_b32 s93, s93, s21
  s_mov_b32 s94, 1835008
  s_cselect_b32 s94, 401408, s94
  s_cselect_b32 s62, s62, 0
  s_and_b32 s93, s93, 0xffff
  s_mov_b32 s95, 0x20000
  s_add_u32 s62, s62, s59
  s_mul_i32 s63, s59, 896
  s_mul_i32 s11, s76, 229376
  s_add_u32 s11, s11, s72
  s_add_u32 m0, s75, 0
  s_add_u32 s77, s11, 0
  buffer_load_dwordx4 v14, s[28:31], s77 offen lds
  s_add_u32 m0, s75, 4096
  s_add_u32 s77, s11, 114688
  buffer_load_dwordx4 v14, s[28:31], s77 offen lds
  v_and_b32 v40, 15, v0
  s_lshl_b32 s56, s53, 5
  s_lshl_b32 s57, s55, 4
  s_add_u32 s78, s56, s57
  v_add_u32 v41, s78, v40
  v_lshlrev_b32 v42, 1, v41
  buffer_load_ushort v43, v42, s[40:43], 0 offen
  buffer_load_ushort v44, v42, s[44:47], 0 offen
  buffer_load_ushort v45, v42, s[68:71], 0 offen
  v_lshrrev_b32 v34, 3, v0
  v_and_b32 v35, 7, v0
  v_mul_u32_u24 v36, 896, v34
  v_lshl_add_u32 v36, v35, 4, v36
  s_cmp_eq_u32 s60, 0
  s_cbranch_scc1 K1_NORB_1
  buffer_load_dwordx4 v[192:195], v36, s[92:95], s63 offen offset:0
  buffer_load_dwordx4 v[196:199], v36, s[92:95], s63 offen offset:128
  buffer_load_dwordx4 v[200:203], v36, s[92:95], s63 offen offset:256
  buffer_load_dwordx4 v[204:207], v36, s[92:95], s63 offen offset:384
  buffer_load_dwordx4 v[208:211], v36, s[92:95], s63 offen offset:512
  buffer_load_dwordx4 v[212:215], v36, s[92:95], s63 offen offset:640
  buffer_load_dwordx4 v[216:219], v36, s[92:95], s63 offen offset:768
K1_NORB_1:
  s_and_b32 s56, s51, 3
  s_lshl_b32 s56, s56, 1
  s_lshr_b32 s57, s51, 2
  s_add_u32 s56, s56, s57
  s_cmp_ge_u32 s56, 6
  s_cselect_b32 s57, 6, 0
  s_sub_u32 s56, s56, s57
  s_cmp_ge_u32 s56, 6
  s_cselect_b32 s57, 6, 0
  s_sub_u32 s56, s56, s57
  s_add_u32 s76, s56, 1
  s_lshl_b32 s5, s76, 7
  s_mul_i32 s12, s76, 229376
  s_add_u32 s5, s5, s66
  s_add_u32 s12, s12, s72
  s_add_u32 s76, s76, 1
  s_cmp_eq_u32 s76, 7
  s_cselect_b32 s76, 1, s76
  s_lshl_b32 s6, s76, 7
  s_mul_i32 s13, s76, 229376
  s_add_u32 s6, s6, s66
  s_add_u32 s13, s13, s72
  s_add_u32 s76, s76, 1
  s_cmp_eq_u32 s76, 7
  s_cselect_b32 s76, 1, s76
  s_lshl_b32 s7, s76, 7
  s_mul_i32 s14, s76, 229376
  s_add_u32 s7, s7, s66
  s_add_u32 s14, s14, s72
  s_add_u32 s76, s76, 1
  s_cmp_eq_u32 s76, 7
  s_cselect_b32 s76, 1, s76
  s_lshl_b32 s8, s76, 7
  s_mul_i32 s15, s76, 229376
  s_add_u32 s8, s8, s66
  s_add_u32 s15, s15, s72
  s_add_u32 s76, s76, 1
  s_cmp_eq_u32 s76, 7
  s_cselect_b32 s76, 1, s76
  s_lshl_b32 s9, s76, 7
  s_mul_i32 s16, s76, 229376
  s_add_u32 s9, s9, s66
  s_add_u32 s16, s16, s72
  s_add_u32 s76, s76, 1
  s_cmp_eq_u32 s76, 7
  s_cselect_b32 s76, 1, s76
  s_lshl_b32 s10, s76, 7
  s_mul_i32 s17, s76, 229376
  s_add_u32 s10, s10, s66
  s_add_u32 s17, s17, s72
  s_add_u32 m0, s73, 16384
  s_nop 0
  buffer_load_dwordx4 v11, s[20:23], s5 offen lds
  s_add_u32 m0, s73, 17408
  s_nop 0
  buffer_load_dwordx4 v12, s[20:23], s5 offen lds
  s_add_u32 m0, s74, 8192
  s_add_u32 s77, s67, s5
  buffer_load_dwordx4 v13, s[24:27], s77 offen lds
  s_add_u32 m0, s75, 16384
  s_add_u32 s77, s12, 0
  buffer_load_dwordx4 v14, s[28:31], s77 offen lds
  s_add_u32 m0, s75, 20480
  s_add_u32 s77, s12, 114688
  buffer_load_dwordx4 v14, s[28:31], s77 offen lds
  v_mov_b32 v122, 0
  s_cmp_lg_u32 s48, 0
  s_cbranch_scc1 K1_NC_2
  s_memrealtime s[100:101]
  s_waitcnt lgkmcnt(0)
  s_or_b32 s99, s100, 1
  v_mov_b32 v120, s99
  v_mov_b32 v121, 0
  s_mov_b64 s[58:59], exec
  s_mov_b64 exec, 1
  buffer_atomic_cmpswap v[120:121], v122, s[36:39], 0 offen sc0
  s_mov_b64 exec, s[58:59]
K1_NC_2:
  v_and_b32 v34, 31, v0
  v_lshrrev_b32 v35, 4, v34
  v_bfe_u32 v36, v34, 2, 1
  v_lshl_add_u32 v35, v36, 1, v35
  v_bfe_u32 v36, v34, 3, 1
  v_lshlrev_b32 v35, 3, v35
  v_lshl_add_u32 v35, v36, 2, v35
  v_and_b32 v36, 3, v34
  v_add_u32 v35, v35, v36
  v_lshrrev_b32 v36, 5, v0
  v_lshl_add_u32 v47, v36, 5, v35
  v_lshlrev_b32 v47, 4, v47
  s_lshl_b32 s56, s54, 5
  v_add_u32 v37, s56, v35
  v_lshlrev_b32 v1, 7, v37
  v_bfe_u32 v38, v35, 1, 3
  v_xor_b32 v38, v38, v36
  v_lshl_add_u32 v1, v38, 4, v1
  v_xor_b32 v2, 32, v1
  v_xor_b32 v3, 64, v1
  v_xor_b32 v4, 96, v1
  v_bfe_u32 v38, v0, 4, 1
  v_lshlrev_b32 v5, 12, v38
  s_lshl_b32 s56, s55, 4
  v_and_b32 v40, 15, v0
  v_add_u32 v39, s56, v40
  v_lshl_add_u32 v5, v39, 7, v5
  v_bfe_u32 v39, v40, 1, 3
  v_xor_b32 v39, v39, v36
  v_lshl_add_u32 v5, v39, 4, v5
  v_add_u32 v5, 49152, v5
  v_xor_b32 v6, 32, v5
  v_xor_b32 v7, 64, v5
  v_xor_b32 v8, 96, v5
  v_lshlrev_b32 v9, 13, v38
  v_lshrrev_b32 v39, 2, v40
  v_lshl_add_u32 v39, v36, 3, v39
  v_lshl_add_u32 v9, v39, 7, v9
  v_lshrrev_b32 v39, 3, v40
  v_lshl_add_u32 v39, v38, 1, v39
  s_lshl_b32 s56, s55, 1
  v_xor_b32 v39, s56, v39
  v_lshl_add_u32 v9, v39, 5, v9
  v_and_b32 v39, 3, v40
  v_lshl_add_u32 v9, v39, 3, v9
  v_add_u32 v9, 73728, v9
  v_xor_b32 v10, 32, v9
  s_lshl_b32 s56, s52, 2
  s_add_u32 s56, s56, s54
  s_mul_i32 s56, s56, 112
  s_lshl_b32 s57, s53, 3
  s_add_u32 s56, s56, s57
  s_lshl_b32 s57, s55, 1
  s_add_u32 s56, s56, s57
  s_lshl_b32 s79, s56, 10
  s_waitcnt vmcnt(8)
  s_waitcnt lgkmcnt(0)
  s_barrier
  ds_read_b128 v[128:131], v1 offset:0
  ds_read_b64_tr_b16 v[104:105], v9 offset:0
  ds_read_b64_tr_b16 v[106:107], v9 offset:512
  ds_read_b128 v[96:99], v5 offset:0
  ds_read_b64_tr_b16 v[108:109], v10 offset:0
  ds_read_b64_tr_b16 v[110:111], v10 offset:512
  s_waitcnt lgkmcnt(3)
  v_mfma_f32_32x32x16_bf16 v[64:79], v[104:107], v[128:131], 0
  ds_read_b128 v[132:135], v2 offset:0
  ds_read_b64_tr_b16 v[112:113], v9 offset:2048
  s_add_u32 m0, s73, 32768
  s_nop 0
  buffer_load_dwordx4 v11, s[20:23], s6 offen lds
  s_waitcnt lgkmcnt(4)
  v_mfma_f32_32x32x16_bf16 v[48:63], v[128:131], v[96:99], 0
  ds_read_b64_tr_b16 v[114:115], v9 offset:2560
  ds_read_b128 v[100:103], v6 offset:0
  s_waitcnt vmcnt(6)
  s_bitcmp1_b32 s54, 0
  s_cselect_b64 s[40:41], -1, 0
  s_bitcmp1_b32 s54, 1
  s_cselect_b64 s[42:43], -1, 0
  s_mov_b32 s44, 0xffff0000
  s_mov_b32 s45, 0xffff0000
  s_mov_b32 s46, 0
  s_mov_b32 s47, -1
  v_lshlrev_b32 v43, 16, v43
  v_lshlrev_b32 v44, 16, v44
  v_lshlrev_b32 v45, 16, v45
  v_mul_f32 v45, 0x3fb8aa3b, v45
  s_waitcnt lgkmcnt(4)
  v_mfma_f32_32x32x16_bf16 v[80:95], v[108:111], v[128:131], 0
  ds_read_b64_tr_b16 v[116:117], v10 offset:2048
  ds_read_b64_tr_b16 v[118:119], v10 offset:2560
  s_add_u32 m0, s73, 33792
  s_nop 0
  buffer_load_dwordx4 v12, s[20:23], s6 offen lds
  s_waitcnt lgkmcnt(3)
  v_mfma_f32_32x32x16_bf16 v[64:79], v[112:115], v[132:135], v[64:79]
  ds_read_b128 v[136:139], v3 offset:0
  ds_read_b64_tr_b16 v[104:105], v9 offset:4096
  v_exp_f32 v45, v45
  s_nop 0
  v_cvt_pk_bf16_f32 v45, v45, v45
  v_lshlrev_b32 v45, 16, v45
  s_waitcnt lgkmcnt(4)
  v_mfma_f32_32x32x16_bf16 v[48:63], v[132:135], v[100:103], v[48:63]
  ds_read_b64_tr_b16 v[106:107], v9 offset:4608
  ds_read_b128 v[96:99], v7 offset:0
  v_mul_f32 v34, v45, v43
  v_mul_f32 v35, v45, v44
  v_mul_f32 v34, 0x3fb8aa3b, v34
  v_exp_f32 v34, v34
  s_waitcnt lgkmcnt(4)
  v_mfma_f32_32x32x16_bf16 v[80:95], v[116:119], v[132:135], v[80:95]
  ds_read_b64_tr_b16 v[108:109], v10 offset:4096
  ds_read_b64_tr_b16 v[110:111], v10 offset:4608
  s_add_u32 m0, s74, 16384
  s_add_u32 s77, s67, s6
  buffer_load_dwordx4 v13, s[24:27], s77 offen lds
  s_waitcnt lgkmcnt(3)
  v_mfma_f32_32x32x16_bf16 v[64:79], v[104:107], v[136:139], v[64:79]
  ds_read_b128 v[140:143], v4 offset:0
  ds_read_b64_tr_b16 v[112:113], v9 offset:6144
  v_mul_f32 v35, 0x3e22f983, v35
  v_fract_f32 v35, v35
  v_cos_f32 v36, v35
  s_waitcnt lgkmcnt(4)
  v_mfma_f32_32x32x16_bf16 v[48:63], v[136:139], v[96:99], v[48:63]
  ds_read_b64_tr_b16 v[114:115], v9 offset:6656
  ds_read_b128 v[100:103], v8 offset:0
  s_cmp_eq_u32 s60, 0
  s_cbranch_scc1 K1_NORC_3
  s_waitcnt vmcnt(8)
  s_mov_b32 s58, 0x3f803f80
  v_mov_b32 v220, 0
  v_mov_b32 v221, 0
  v_mov_b32 v222, 0
  v_mov_b32 v223, 0
  v_dot2c_f32_bf16 v220, s58, v192
  v_dot2c_f32_bf16 v222, v192, v192
  v_dot2c_f32_bf16 v221, s58, v193
  v_dot2c_f32_bf16 v223, v193, v193
  v_dot2c_f32_bf16 v220, s58, v194
  v_dot2c_f32_bf16 v222, v194, v194
  v_dot2c_f32_bf16 v221, s58, v195
  v_dot2c_f32_bf16 v223, v195, v195
  v_dot2c_f32_bf16 v220, s58, v196
  v_dot2c_f32_bf16 v222, v196, v196
  v_dot2c_f32_bf16 v221, s58, v197
  v_dot2c_f32_bf16 v223, v197, v197
  v_dot2c_f32_bf16 v220, s58, v198
  v_dot2c_f32_bf16 v222, v198, v198
  v_dot2c_f32_bf16 v221, s58, v199
  v_dot2c_f32_bf16 v223, v199, v199
  v_dot2c_f32_bf16 v220, s58, v200
  v_dot2c_f32_bf16 v222, v200, v200
  v_dot2c_f32_bf16 v221, s58, v201
  v_dot2c_f32_bf16 v223, v201, v201
  v_dot2c_f32_bf16 v220, s58, v202
  v_dot2c_f32_bf16 v222, v202, v202
  v_dot2c_f32_bf16 v221, s58, v203
  v_dot2c_f32_bf16 v223, v203, v203
  v_dot2c_f32_bf16 v220, s58, v204
  v_dot2c_f32_bf16 v222, v204, v204
  v_dot2c_f32_bf16 v221, s58, v205
  v_dot2c_f32_bf16 v223, v205, v205
  v_dot2c_f32_bf16 v220, s58, v206
  v_dot2c_f32_bf16 v222, v206, v206
  v_dot2c_f32_bf16 v221, s58, v207
  v_dot2c_f32_bf16 v223, v207, v207
  v_dot2c_f32_bf16 v220, s58, v208
  v_dot2c_f32_bf16 v222, v208, v208
  v_dot2c_f32_bf16 v221, s58, v209
  v_dot2c_f32_bf16 v223, v209, v209
  v_dot2c_f32_bf16 v220, s58, v210
  v_dot2c_f32_bf16 v222, v210, v210
  v_dot2c_f32_bf16 v221, s58, v211
  v_dot2c_f32_bf16 v223, v211, v211
  v_dot2c_f32_bf16 v220, s58, v212
  v_dot2c_f32_bf16 v222, v212, v212
  v_dot2c_f32_bf16 v221, s58, v213
  v_dot2c_f32_bf16 v223, v213, v213
  v_dot2c_f32_bf16 v220, s58, v214
  v_dot2c_f32_bf16 v222, v214, v214
  v_dot2c_f32_bf16 v221, s58, v215
  v_dot2c_f32_bf16 v223, v215, v215
  v_dot2c_f32_bf16 v220, s58, v216
  v_dot2c_f32_bf16 v222, v216, v216
  v_dot2c_f32_bf16 v221, s58, v217
  v_dot2c_f32_bf16 v223, v217, v217
  v_dot2c_f32_bf16 v220, s58, v218
  v_dot2c_f32_bf16 v222, v218, v218
  v_dot2c_f32_bf16 v221, s58, v219
  v_dot2c_f32_bf16 v223, v219, v219
  s_nop 2
  v_add_f32 v220, v220, v221
  v_add_f32 v221, v222, v223
  s_nop 0
  v_add_f32_dpp v220, v220, v220 quad_perm:[1,0,3,2] row_mask:0xf bank_mask:0xf
  s_nop 1
  v_add_f32_dpp v220, v220, v220 quad_perm:[2,3,0,1] row_mask:0xf bank_mask:0xf
  s_nop 1
  v_add_f32_dpp v220, v220, v220 row_half_mirror row_mask:0xf bank_mask:0xf
  v_add_f32_dpp v221, v221, v221 quad_perm:[1,0,3,2] row_mask:0xf bank_mask:0xf
  s_nop 1
  v_add_f32_dpp v221, v221, v221 quad_perm:[2,3,0,1] row_mask:0xf bank_mask:0xf
  s_nop 1
  v_add_f32_dpp v221, v221, v221 row_half_mirror row_mask:0xf bank_mask:0xf
  v_mov_b32 v224, v220
  v_mul_f32 v220, 0x3b124925, v220
  v_mul_f32 v221, 0x3b124925, v221
  v_fma_f32 v221, -v220, v220, v221
  v_max_f32 v221, 0, v221
  v_cvt_pk_bf16_f32 v220, v220, v221
  v_and_b32 v221, 0xffff0000, v220
  v_lshlrev_b32 v220, 16, v220
  v_add_f32 v221, 0x3727c5ac, v221
  v_cvt_pk_bf16_f32 v221, v221, v221
  v_lshlrev_b32 v221, 16, v221
  v_sqrt_f32 v221, v221
  s_nop 0
  v_cvt_pk_bf16_f32 v221, v221, v221
  v_lshlrev_b32 v221, 16, v221
K1_NORC_3:
  v_sin_f32 v37, v35
  v_mul_f32 v15, v34, v36
  v_mul_f32 v16, v34, v37
  s_waitcnt lgkmcnt(4)
  v_mfma_f32_32x32x16_bf16 v[80:95], v[108:111], v[136:139], v[80:95]
  ds_read_b64_tr_b16 v[116:117], v10 offset:6144
  ds_read_b64_tr_b16 v[118:119], v10 offset:6656
  s_add_u32 m0, s75, 32768
  s_add_u32 s77, s13, 0
  buffer_load_dwordx4 v14, s[28:31], s77 offen lds
  s_waitcnt lgkmcnt(3)
  v_mfma_f32_32x32x16_bf16 v[64:79], v[112:115], v[140:143], v[64:79]
  s_waitcnt vmcnt(4)
  s_cmp_lg_u32 s48, 0
  s_cbranch_scc1 K1_NP_4
  s_waitcnt vmcnt(4)
  v_readfirstlane_b32 s100, v120
  s_nop 1
  s_cmp_eq_u32 s100, 0
  s_cselect_b32 s100, s99, s100
  v_mov_b32 v120, s100
  v_mov_b32 v121, 142336
  ds_write_b32 v121, v120
  s_waitcnt lgkmcnt(0)
K1_NP_4:
  s_waitcnt lgkmcnt(0)
  s_barrier
  v_mov_b32 v121, 142336
  ds_read_b32 v121, v121
  s_waitcnt lgkmcnt(0)
  v_readfirstlane_b32 s98, v121
  ds_read_b128 v[144:147], v1 offset:16384
  ds_read_b64_tr_b16 v[104:105], v9 offset:16384
  s_add_u32 m0, s75, 36864
  s_add_u32 s77, s13, 114688
  buffer_load_dwordx4 v14, s[28:31], s77 offen lds
  v_mfma_f32_32x32x16_bf16 v[48:63], v[140:143], v[100:103], v[48:63]
  ds_read_b64_tr_b16 v[106:107], v9 offset:16896
  ds_read_b128 v[96:99], v5 offset:8192
  s_add_u32 m0, s75, 49152
  s_add_u32 s77, s14, 0
  buffer_load_dwordx4 v14, s[28:31], s77 offen lds
  v_mfma_f32_32x32x16_bf16 v[80:95], v[116:119], v[140:143], v[80:95]
  ds_read_b64_tr_b16 v[108:109], v10 offset:16384
  ds_read_b64_tr_b16 v[110:111], v10 offset:16896
  s_add_u32 m0, s75, 53248
  s_add_u32 s77, s14, 114688
  buffer_load_dwordx4 v14, s[28:31], s77 offen lds
  s_cmp_eq_u32 s60, 0
  s_cbranch_scc1 K1_NORP_5
  v_lshrrev_b32 v226, 3, v0
  v_add_u32 v226, s62, v226
  v_and_b32 v227, 7, v0
  v_cmp_eq_u32 vcc, 0, v227
  s_nop 1
  s_and_saveexec_b64 s[58:59], vcc
  s_cmp_eq_u32 s60, 1
  s_cbranch_scc1 K1_RPX_6
  v_lshlrev_b32 v226, 3, v226
  v_mov_b32 v228, v224
  v_mov_b32 v229, s98
  s_mov_b32 s61, 11071488
  buffer_store_dwordx2 v[228:229], v226, s[32:35], s61 offen sc1
  s_mov_b64 exec, s[58:59]
  s_branch K1_NORP_5
K1_RPX_6:
  v_lshlrev_b32 v226, 4, v226
  v_mov_b32 v228, v220
  v_mov_b32 v229, s98
  v_mov_b32 v230, v221
  v_mov_b32 v231, s98
  s_mov_b32 s61, 11010048
  buffer_store_dwordx4 v[228:231], v226, s[32:35], s61 offen sc1
  s_mov_b64 exec, s[58:59]
K1_NORP_5:
  s_waitcnt lgkmcnt(3)
  v_mfma_f32_32x32x16_bf16 v[64:79], v[104:107], v[144:147], v[64:79]
  ds_read_b128 v[148:151], v2 offset:16384
  ds_read_b64_tr_b16 v[112:113], v9 offset:18432
  v_add_f32 v36, -1.0, v15
  v_mul_f32 v38, v43, v43
  v_fmac_f32 v38, v44, v44
  v_rcp_f32 v38, v38
  s_waitcnt lgkmcnt(4)
  v_mfma_f32_32x32x16_bf16 v[48:63], v[144:147], v[96:99], v[48:63]
  ds_read_b64_tr_b16 v[114:115], v9 offset:18944
  ds_read_b128 v[100:103], v6 offset:8192
  v_mul_f32 v39, v36, v43
  v_fmac_f32 v39, v16, v44
  v_mul_f32 v34, v16, v43
  v_fma_f32 v34, -v36, v44, v34
  s_waitcnt lgkmcnt(4)
  v_mfma_f32_32x32x16_bf16 v[80:95], v[108:111], v[144:147], v[80:95]
  ds_read_b64_tr_b16 v[116:117], v10 offset:18432
  ds_read_b64_tr_b16 v[118:119], v10 offset:18944
  s_add_u32 m0, s73, 0
  s_nop 0
  buffer_load_dwordx4 v11, s[20:23], s7 offen lds
  s_waitcnt lgkmcnt(3)
  v_mfma_f32_32x32x16_bf16 v[64:79], v[112:115], v[148:151], v[64:79]
  ds_read_b128 v[152:155], v3 offset:16384
  ds_read_b64_tr_b16 v[104:105], v9 offset:20480
  v_add_f32 v38, v38, v38
  v_mul_f32 v17, v39, v38
  v_mul_f32 v18, v34, v38
  v_mul_f32 v38, v16, v16
  s_waitcnt lgkmcnt(4)
  v_mfma_f32_32x32x16_bf16 v[48:63], v[148:151], v[100:103], v[48:63]
  ds_read_b64_tr_b16 v[106:107], v9 offset:20992
  ds_read_b128 v[96:99], v7 offset:8192
  v_mul_f32 v39, v15, v16
  v_fma_f32 v34, v15, v15, -v38
  v_add_f32 v35, v39, v39
  v_mul_f32 v38, v35, v35
  s_waitcnt lgkmcnt(4)
  v_mfma_f32_32x32x16_bf16 v[80:95], v[116:119], v[148:151], v[80:95]
  ds_read_b64_tr_b16 v[108:109], v10 offset:20480
  ds_read_b64_tr_b16 v[110:111], v10 offset:20992
  s_add_u32 m0, s73, 1024
  s_nop 0
  buffer_load_dwordx4 v12, s[20:23], s7 offen lds
  s_waitcnt lgkmcnt(3)
  v_mfma_f32_32x32x16_bf16 v[64:79], v[104:107], v[152:155], v[64:79]
  ds_read_b128 v[156:159], v4 offset:16384
  ds_read_b64_tr_b16 v[112:113], v9 offset:22528
  v_mul_f32 v39, v34, v35
  v_fma_f32 v36, v34, v34, -v38
  v_add_f32 v37, v39, v39
  v_mul_f32 v38, v37, v37
  s_waitcnt lgkmcnt(4)
  v_mfma_f32_32x32x16_bf16 v[48:63], v[152:155], v[96:99], v[48:63]
  ds_read_b64_tr_b16 v[114:115], v9 offset:23040
  ds_read_b128 v[100:103], v8 offset:8192
  v_mul_f32 v39, v36, v37
  v_fma_f32 v19, v36, v36, -v38
  v_add_f32 v20, v39, v39
  v_mov_b32 v23, 1.0
  s_waitcnt lgkmcnt(4)
  v_mfma_f32_32x32x16_bf16 v[80:95], v[108:111], v[152:155], v[80:95]
  ds_read_b64_tr_b16 v[116:117], v10 offset:22528
  ds_read_b64_tr_b16 v[118:119], v10 offset:23040
  s_add_u32 m0, s74, 0
  s_add_u32 s77, s67, s7
  buffer_load_dwordx4 v13, s[24:27], s77 offen lds
  s_waitcnt lgkmcnt(3)
  v_mfma_f32_32x32x16_bf16 v[64:79], v[112:115], v[156:159], v[64:79]
  s_waitcnt vmcnt(5)
  s_waitcnt lgkmcnt(0)
  s_barrier
  ds_read_b128 v[160:163], v1 offset:32768
  ds_read_b64_tr_b16 v[104:105], v9 offset:32768
  s_add_u32 m0, s75, 0
  s_add_u32 s77, s15, 0
  buffer_load_dwordx4 v14, s[28:31], s77 offen lds
  v_mfma_f32_32x32x16_bf16 v[48:63], v[156:159], v[100:103], v[48:63]
  ds_read_b64_tr_b16 v[106:107], v9 offset:33280
  ds_read_b128 v[96:99], v5 offset:16384
  v_mov_b32 v24, 0
  v_mov_b32 v34, v19
  v_mov_b32 v35, v20
  v_mul_f32 v38, v24, v35
  v_mfma_f32_32x32x16_bf16 v[80:95], v[116:119], v[156:159], v[80:95]
  ds_read_b64_tr_b16 v[108:109], v10 offset:32768
  ds_read_b64_tr_b16 v[110:111], v10 offset:33280
  s_add_u32 m0, s75, 4096
  s_add_u32 s77, s15, 114688
  buffer_load_dwordx4 v14, s[28:31], s77 offen lds
  s_waitcnt lgkmcnt(3)
  v_mfma_f32_32x32x16_bf16 v[64:79], v[104:107], v[160:163], v[64:79]
  ds_read_b128 v[164:167], v2 offset:32768
  ds_read_b64_tr_b16 v[112:113], v9 offset:34816
  v_mul_f32 v39, v24, v34
  v_fma_f32 v38, v23, v34, -v38
  v_fma_f32 v37, v23, v35, v39
  v_mov_b32 v36, v38
  s_waitcnt lgkmcnt(4)
  v_mfma_f32_32x32x16_bf16 v[48:63], v[160:163], v[96:99], v[48:63]
  ds_read_b64_tr_b16 v[114:115], v9 offset:35328
  ds_read_b128 v[100:103], v6 offset:16384
  v_cndmask_b32 v23, v23, v36, s[44:45]
  v_cndmask_b32 v24, v24, v37, s[44:45]
  v_mov_b32 v41, v34
  v_mov_b32 v42, v35
  s_waitcnt lgkmcnt(4)
  v_mfma_f32_32x32x16_bf16 v[80:95], v[108:111], v[160:163], v[80:95]
  ds_read_b64_tr_b16 v[116:117], v10 offset:34816
  ds_read_b64_tr_b16 v[118:119], v10 offset:35328
  s_add_u32 m0, s73, 16384
  s_nop 0
  buffer_load_dwordx4 v11, s[20:23], s8 offen lds
  s_waitcnt lgkmcnt(3)
  v_mfma_f32_32x32x16_bf16 v[64:79], v[112:115], v[164:167], v[64:79]
  ds_read_b128 v[168:171], v3 offset:32768
  ds_read_b64_tr_b16 v[104:105], v9 offset:36864
  v_mul_f32 v38, v42, v42
  v_mul_f32 v39, v41, v42
  v_fma_f32 v34, v41, v41, -v38
  v_add_f32 v35, v39, v39
  s_waitcnt lgkmcnt(4)
  v_mfma_f32_32x32x16_bf16 v[48:63], v[164:167], v[100:103], v[48:63]
  ds_read_b64_tr_b16 v[106:107], v9 offset:37376
  ds_read_b128 v[96:99], v7 offset:16384
  v_mul_f32 v38, v24, v35
  v_mul_f32 v39, v24, v34
  v_fma_f32 v38, v23, v34, -v38
  v_fma_f32 v37, v23, v35, v39
  s_waitcnt lgkmcnt(4)
  v_mfma_f32_32x32x16_bf16 v[80:95], v[116:119], v[164:167], v[80:95]
  ds_read_b64_tr_b16 v[108:109], v10 offset:36864
  ds_read_b64_tr_b16 v[110:111], v10 offset:37376
  s_add_u32 m0, s73, 17408
  s_nop 0
  buffer_load_dwordx4 v12, s[20:23], s8 offen lds
  s_waitcnt lgkmcnt(3)
  v_mfma_f32_32x32x16_bf16 v[64:79], v[104:107], v[168:171], v[64:79]
  ds_read_b128 v[172:175], v4 offset:32768
  ds_read_b64_tr_b16 v[112:113], v9 offset:38912
  v_mov_b32 v36, v38
  v_cndmask_b32 v23, v23, v36, s[46:47]
  v_cndmask_b32 v24, v24, v37, s[46:47]
  v_mov_b32 v41, v34
  s_waitcnt lgkmcnt(4)
  v_mfma_f32_32x32x16_bf16 v[48:63], v[168:171], v[96:99], v[48:63]
  ds_read_b64_tr_b16 v[114:115], v9 offset:39424
  ds_read_b128 v[100:103], v8 offset:16384
  v_mov_b32 v42, v35
  v_mul_f32 v38, v42, v42
  v_mul_f32 v39, v41, v42
  v_fma_f32 v34, v41, v41, -v38
  s_waitcnt lgkmcnt(4)
  v_mfma_f32_32x32x16_bf16 v[80:95], v[108:111], v[168:171], v[80:95]
  ds_read_b64_tr_b16 v[116:117], v10 offset:38912
  ds_read_b64_tr_b16 v[118:119], v10 offset:39424
  s_add_u32 m0, s74, 8192
  s_add_u32 s77, s67, s8
  buffer_load_dwordx4 v13, s[24:27], s77 offen lds
  s_waitcnt lgkmcnt(3)
  v_mfma_f32_32x32x16_bf16 v[64:79], v[112:115], v[172:175], v[64:79]
  s_waitcnt vmcnt(5)
  s_waitcnt lgkmcnt(0)
  s_barrier
  ds_read_b128 v[176:179], v1 offset:0
  ds_read_b64_tr_b16 v[104:105], v9 offset:49152
  s_add_u32 m0, s75, 16384
  s_add_u32 s77, s16, 0
  buffer_load_dwordx4 v14, s[28:31], s77 offen lds
  v_mfma_f32_32x32x16_bf16 v[48:63], v[172:175], v[100:103], v[48:63]
  ds_read_b64_tr_b16 v[106:107], v9 offset:49664
  ds_read_b128 v[96:99], v5 offset:0
  v_add_f32 v35, v39, v39
  v_mul_f32 v38, v24, v35
  v_mul_f32 v39, v24, v34
  v_fma_f32 v38, v23, v34, -v38
  v_mfma_f32_32x32x16_bf16 v[80:95], v[116:119], v[172:175], v[80:95]
  ds_read_b64_tr_b16 v[108:109], v10 offset:49152
  ds_read_b64_tr_b16 v[110:111], v10 offset:49664
  s_add_u32 m0, s75, 20480
  s_add_u32 s77, s16, 114688
  buffer_load_dwordx4 v14, s[28:31], s77 offen lds
  s_waitcnt lgkmcnt(3)
  v_mfma_f32_32x32x16_bf16 v[64:79], v[104:107], v[176:179], v[64:79]
  ds_read_b128 v[180:183], v2 offset:0
  ds_read_b64_tr_b16 v[112:113], v9 offset:51200
  v_fma_f32 v37, v23, v35, v39
  v_mov_b32 v36, v38
  v_cndmask_b32 v23, v23, v36, s[40:41]
  v_cndmask_b32 v24, v24, v37, s[40:41]
  s_waitcnt lgkmcnt(4)
  v_mfma_f32_32x32x16_bf16 v[48:63], v[176:179], v[96:99], v[48:63]
  ds_read_b64_tr_b16 v[114:115], v9 offset:51712
  ds_read_b128 v[100:103], v6 offset:0
  v_mov_b32 v41, v34
  v_mov_b32 v42, v35
  v_mul_f32 v38, v42, v42
  v_mul_f32 v39, v41, v42
  s_waitcnt lgkmcnt(4)
  v_mfma_f32_32x32x16_bf16 v[80:95], v[108:111], v[176:179], v[80:95]
  ds_read_b64_tr_b16 v[116:117], v10 offset:51200
  ds_read_b64_tr_b16 v[118:119], v10 offset:51712
  s_add_u32 m0, s73, 32768
  s_nop 0
  buffer_load_dwordx4 v11, s[20:23], s9 offen lds
  s_waitcnt lgkmcnt(3)
  v_mfma_f32_32x32x16_bf16 v[64:79], v[112:115], v[180:183], v[64:79]
  ds_read_b128 v[184:187], v3 offset:0
  ds_read_b64_tr_b16 v[104:105], v9 offset:53248
  v_fma_f32 v34, v41, v41, -v38
  v_add_f32 v35, v39, v39
  v_mul_f32 v38, v24, v35
  v_mul_f32 v39, v24, v34
  s_waitcnt lgkmcnt(4)
  v_mfma_f32_32x32x16_bf16 v[48:63], v[180:183], v[100:103], v[48:63]
  ds_read_b64_tr_b16 v[106:107], v9 offset:53760
  ds_read_b128 v[96:99], v7 offset:0
  v_fma_f32 v38, v23, v34, -v38
  v_fma_f32 v37, v23, v35, v39
  v_mov_b32 v36, v38
  v_cndmask_b32 v23, v23, v36, s[42:43]
  s_waitcnt lgkmcnt(4)
  v_mfma_f32_32x32x16_bf16 v[80:95], v[116:119], v[180:183], v[80:95]
  ds_read_b64_tr_b16 v[108:109], v10 offset:53248
  ds_read_b64_tr_b16 v[110:111], v10 offset:53760
  s_add_u32 m0, s73, 33792
  s_nop 0
  buffer_load_dwordx4 v12, s[20:23], s9 offen lds
  s_waitcnt lgkmcnt(3)
  v_mfma_f32_32x32x16_bf16 v[64:79], v[104:107], v[184:187], v[64:79]
  ds_read_b128 v[188:191], v4 offset:0
  ds_read_b64_tr_b16 v[112:113], v9 offset:55296
  v_cndmask_b32 v24, v24, v37, s[42:43]
  v_mov_b32 v41, v34
  v_mov_b32 v42, v35
  v_mul_f32 v38, v42, v42
  s_waitcnt lgkmcnt(4)
  v_mfma_f32_32x32x16_bf16 v[48:63], v[184:187], v[96:99], v[48:63]
  ds_read_b64_tr_b16 v[114:115], v9 offset:55808
  ds_read_b128 v[100:103], v8 offset:0
  v_mul_f32 v39, v41, v42
  v_fma_f32 v34, v41, v41, -v38
  v_add_f32 v35, v39, v39
  v_mov_b32 v21, v34
  s_waitcnt lgkmcnt(4)
  v_mfma_f32_32x32x16_bf16 v[80:95], v[108:111], v[184:187], v[80:95]
  ds_read_b64_tr_b16 v[116:117], v10 offset:55296
  ds_read_b64_tr_b16 v[118:119], v10 offset:55808
  s_add_u32 m0, s74, 16384
  s_add_u32 s77, s67, s9
  buffer_load_dwordx4 v13, s[24:27], s77 offen lds
  s_waitcnt lgkmcnt(3)
  v_mfma_f32_32x32x16_bf16 v[64:79], v[112:115], v[188:191], v[64:79]
  s_waitcnt vmcnt(5)
  s_waitcnt lgkmcnt(0)
  s_barrier
  ds_read_b128 v[192:195], v1 offset:16384
  ds_read_b64_tr_b16 v[104:105], v9 offset:0
  s_add_u32 m0, s75, 32768
  s_add_u32 s77, s17, 0
  buffer_load_dwordx4 v14, s[28:31], s77 offen lds
  v_mfma_f32_32x32x16_bf16 v[48:63], v[188:191], v[100:103], v[48:63]
  ds_read_b64_tr_b16 v[106:107], v9 offset:512
  ds_read_b128 v[96:99], v5 offset:8192
  v_mov_b32 v22, v35
  v_mfma_f32_32x32x16_bf16 v[80:95], v[116:119], v[188:191], v[80:95]
  ds_read_b64_tr_b16 v[108:109], v10 offset:0
  ds_read_b64_tr_b16 v[110:111], v10 offset:512
  s_add_u32 m0, s75, 36864
  s_add_u32 s77, s17, 114688
  buffer_load_dwordx4 v14, s[28:31], s77 offen lds
  s_waitcnt lgkmcnt(3)
  v_mfma_f32_32x32x16_bf16 v[64:79], v[104:107], v[192:195], v[64:79]
  ds_read_b128 v[196:199], v2 offset:16384
  ds_read_b64_tr_b16 v[112:113], v9 offset:2048
  s_waitcnt lgkmcnt(4)
  v_mfma_f32_32x32x16_bf16 v[48:63], v[192:195], v[96:99], v[48:63]
  ds_read_b64_tr_b16 v[114:115], v9 offset:2560
  ds_read_b128 v[100:103], v6 offset:8192
  s_waitcnt lgkmcnt(4)
  v_mfma_f32_32x32x16_bf16 v[80:95], v[108:111], v[192:195], v[80:95]
  ds_read_b64_tr_b16 v[116:117], v10 offset:2048
  ds_read_b64_tr_b16 v[118:119], v10 offset:2560
  s_add_u32 m0, s73, 0
  s_nop 0
  buffer_load_dwordx4 v11, s[20:23], s10 offen lds
  s_cmp_lg_u32 s48, 3
  s_cbranch_scc1 K1_A1I_7
  s_lshl_b32 s61, s52, 11
  s_add_u32 s61, s61, 11010048
  v_lshlrev_b32 v120, 4, v0
  buffer_load_dwordx4 v[36:39], v120, s[32:35], s61 offen sc1
  buffer_load_dwordx4 v[40:43], v120, s[32:35], s61 offen offset:1024 sc1
  v_lshrrev_b32 v121, 5, v0
  v_mul_u32_u24 v121, 448, v121
  v_and_b32 v122, 31, v0
  v_add_u32 v121, v121, v122
  s_lshl_b32 s61, s53, 5
  v_add_u32 v121, s61, v121
  v_lshlrev_b32 v121, 3, v121
  s_mov_b32 s61, 11071488
  buffer_load_dwordx2 v[124:125], v121, s[32:35], s61 offen sc1
K1_A1I_7:
  s_waitcnt lgkmcnt(3)
  v_mfma_f32_32x32x16_bf16 v[64:79], v[112:115], v[196:199], v[64:79]
  ds_read_b128 v[200:203], v3 offset:16384
  ds_read_b64_tr_b16 v[104:105], v9 offset:4096
  s_waitcnt lgkmcnt(4)
  v_mfma_f32_32x32x16_bf16 v[48:63], v[196:199], v[100:103], v[48:63]
  ds_read_b64_tr_b16 v[106:107], v9 offset:4608
  ds_read_b128 v[96:99], v7 offset:8192
  s_waitcnt lgkmcnt(4)
  v_mfma_f32_32x32x16_bf16 v[80:95], v[116:119], v[196:199], v[80:95]
  ds_read_b64_tr_b16 v[108:109], v10 offset:4096
  ds_read_b64_tr_b16 v[110:111], v10 offset:4608
  s_add_u32 m0, s73, 1024
  s_nop 0
  buffer_load_dwordx4 v12, s[20:23], s10 offen lds
  s_waitcnt lgkmcnt(3)
  v_mfma_f32_32x32x16_bf16 v[64:79], v[104:107], v[200:203], v[64:79]
  ds_read_b128 v[204:207], v4 offset:16384
  ds_read_b64_tr_b16 v[112:113], v9 offset:6144
  s_waitcnt lgkmcnt(4)
  v_mfma_f32_32x32x16_bf16 v[48:63], v[200:203], v[96:99], v[48:63]
  ds_read_b64_tr_b16 v[114:115], v9 offset:6656
  ds_read_b128 v[100:103], v8 offset:8192
  s_waitcnt lgkmcnt(4)
  v_mfma_f32_32x32x16_bf16 v[80:95], v[108:111], v[200:203], v[80:95]
  ds_read_b64_tr_b16 v[116:117], v10 offset:6144
  ds_read_b64_tr_b16 v[118:119], v10 offset:6656
  s_add_u32 m0, s74, 0
  s_add_u32 s77, s67, s10
  buffer_load_dwordx4 v13, s[24:27], s77 offen lds
  s_waitcnt lgkmcnt(3)
  v_mfma_f32_32x32x16_bf16 v[64:79], v[112:115], v[204:207], v[64:79]
  s_waitcnt vmcnt(5)
  s_waitcnt lgkmcnt(0)
  s_barrier
  ds_read_b128 v[208:211], v1 offset:32768
  ds_read_b64_tr_b16 v[104:105], v9 offset:16384
  v_mfma_f32_32x32x16_bf16 v[48:63], v[204:207], v[100:103], v[48:63]
  ds_read_b64_tr_b16 v[106:107], v9 offset:16896
  ds_read_b128 v[96:99], v5 offset:16384
  v_mfma_f32_32x32x16_bf16 v[80:95], v[116:119], v[204:207], v[80:95]
  ds_read_b64_tr_b16 v[108:109], v10 offset:16384
  ds_read_b64_tr_b16 v[110:111], v10 offset:16896
  s_add_u32 m0, s75, 49152
  s_add_u32 s77, s11, 128
  buffer_load_dwordx4 v14, s[28:31], s77 offen lds
  s_waitcnt lgkmcnt(3)
  v_mfma_f32_32x32x16_bf16 v[64:79], v[104:107], v[208:211], v[64:79]
  ds_read_b128 v[212:215], v2 offset:32768
  ds_read_b64_tr_b16 v[112:113], v9 offset:18432
  s_waitcnt lgkmcnt(4)
  v_mfma_f32_32x32x16_bf16 v[48:63], v[208:211], v[96:99], v[48:63]
  ds_read_b64_tr_b16 v[114:115], v9 offset:18944
  ds_read_b128 v[100:103], v6 offset:16384
  s_waitcnt lgkmcnt(4)
  v_mfma_f32_32x32x16_bf16 v[80:95], v[108:111], v[208:211], v[80:95]
  ds_read_b64_tr_b16 v[116:117], v10 offset:18432
  ds_read_b64_tr_b16 v[118:119], v10 offset:18944
  s_add_u32 m0, s75, 53248
  s_add_u32 s77, s11, 114816
  buffer_load_dwordx4 v14, s[28:31], s77 offen lds
  s_waitcnt lgkmcnt(3)
  v_mfma_f32_32x32x16_bf16 v[64:79], v[112:115], v[212:215], v[64:79]
  ds_read_b128 v[216:219], v3 offset:32768
  ds_read_b64_tr_b16 v[104:105], v9 offset:20480
  s_waitcnt lgkmcnt(4)
  v_mfma_f32_32x32x16_bf16 v[48:63], v[212:215], v[100:103], v[48:63]
  ds_read_b64_tr_b16 v[106:107], v9 offset:20992
  ds_read_b128 v[96:99], v7 offset:16384
  s_waitcnt lgkmcnt(4)
  v_mfma_f32_32x32x16_bf16 v[80:95], v[116:119], v[212:215], v[80:95]
  ds_read_b64_tr_b16 v[108:109], v10 offset:20480
  ds_read_b64_tr_b16 v[110:111], v10 offset:20992
  s_add_u32 m0, s75, 0
  s_add_u32 s77, s12, 128
  buffer_load_dwordx4 v14, s[28:31], s77 offen lds
  s_waitcnt lgkmcnt(3)
  v_mfma_f32_32x32x16_bf16 v[64:79], v[104:107], v[216:219], v[64:79]
  ds_read_b128 v[220:223], v4 offset:32768
  ds_read_b64_tr_b16 v[112:113], v9 offset:22528
  s_waitcnt lgkmcnt(4)
  v_mfma_f32_32x32x16_bf16 v[48:63], v[216:219], v[96:99], v[48:63]
  ds_read_b64_tr_b16 v[114:115], v9 offset:23040
  ds_read_b128 v[100:103], v8 offset:16384
  s_waitcnt lgkmcnt(4)
  v_mfma_f32_32x32x16_bf16 v[80:95], v[108:111], v[216:219], v[80:95]
  ds_read_b64_tr_b16 v[116:117], v10 offset:22528
  ds_read_b64_tr_b16 v[118:119], v10 offset:23040
  s_add_u32 m0, s75, 4096
  s_add_u32 s77, s12, 114816
  buffer_load_dwordx4 v14, s[28:31], s77 offen lds
  s_cmp_lg_u32 s48, 3
  s_cbranch_scc1 K1_A1F_8
  s_waitcnt vmcnt(6)
  v_xor_b32 v44, s98, v37
  v_xor_b32 v45, s98, v39
  v_or_b32 v44, v44, v45
  v_xor_b32 v45, s98, v41
  v_or_b32 v44, v44, v45
  v_xor_b32 v45, s98, v43
  v_or_b32 v44, v44, v45
  v_xor_b32 v45, s98, v125
  v_or_b32 v44, v44, v45
  v_cmp_ne_u32 vcc, 0, v44
  s_nop 1
  s_cmp_eq_u64 vcc, 0
  s_cbranch_scc1 K1_A1_OK_9
  s_mov_b32 s63, 0
K1_A1_RT_10:
  s_lshl_b32 s61, s52, 11
  s_add_u32 s61, s61, 11010048
  v_lshlrev_b32 v120, 4, v0
  buffer_load_dwordx4 v[36:39], v120, s[32:35], s61 offen sc1
  buffer_load_dwordx4 v[40:43], v120, s[32:35], s61 offen offset:1024 sc1
  v_lshrrev_b32 v121, 5, v0
  v_mul_u32_u24 v121, 448, v121
  v_and_b32 v122, 31, v0
  v_add_u32 v121, v121, v122
  s_lshl_b32 s61, s53, 5
  v_add_u32 v121, s61, v121
  v_lshlrev_b32 v121, 3, v121
  s_mov_b32 s61, 11071488
  buffer_load_dwordx2 v[124:125], v121, s[32:35], s61 offen sc1
  s_waitcnt vmcnt(0)
  v_xor_b32 v44, s98, v37
  v_xor_b32 v45, s98, v39
  v_or_b32 v44, v44, v45
  v_xor_b32 v45, s98, v41
  v_or_b32 v44, v44, v45
  v_xor_b32 v45, s98, v43
  v_or_b32 v44, v44, v45
  v_xor_b32 v45, s98, v125
  v_or_b32 v44, v44, v45
  v_cmp_ne_u32 vcc, 0, v44
  s_nop 1
  s_cmp_eq_u64 vcc, 0
  s_cbranch_scc1 K1_A1_OK_9
  s_add_u32 s63, s63, 1
  s_cmp_lt_u32 s63, 100000
  s_cbranch_scc1 K1_A1_RT_10
K1_A1_OK_9:
  v_rcp_f32 v37, v38
  v_rcp_f32 v41, v42
  v_lshlrev_b32 v120, 3, v0
  v_add_u32 v120, 139264, v120
  ds_write_b64 v120, v[36:37]
  ds_write_b64 v120, v[40:41] offset:512
  v_lshlrev_b32 v120, 2, v0
  v_add_u32 v120, 142592, v120
  ds_write_b32 v120, v38
  ds_write_b32 v120, v42 offset:256
  ds_write_b32 v120, v124 offset:512
  s_waitcnt lgkmcnt(0)
K1_A1F_8:
  s_waitcnt lgkmcnt(3)
  v_mfma_f32_32x32x16_bf16 v[64:79], v[112:115], v[220:223], v[64:79]
  s_waitcnt vmcnt(4)
  s_waitcnt lgkmcnt(0)
  s_barrier
  ds_read_b128 v[224:227], v1 offset:0
  ds_read_b64_tr_b16 v[104:105], v9 offset:32768
  v_mfma_f32_32x32x16_bf16 v[48:63], v[220:223], v[100:103], v[48:63]
  ds_read_b64_tr_b16 v[106:107], v9 offset:33280
  ds_read_b128 v[96:99], v5 offset:0
  v_mfma_f32_32x32x16_bf16 v[80:95], v[116:119], v[220:223], v[80:95]
  ds_read_b64_tr_b16 v[108:109], v10 offset:32768
  ds_read_b64_tr_b16 v[110:111], v10 offset:33280
  s_add_u32 m0, s75, 16384
  s_add_u32 s77, s13, 128
  buffer_load_dwordx4 v14, s[28:31], s77 offen lds
  s_waitcnt lgkmcnt(3)
  v_mfma_f32_32x32x16_bf16 v[64:79], v[104:107], v[224:227], v[64:79]
  ds_read_b128 v[228:231], v2 offset:0
  ds_read_b64_tr_b16 v[112:113], v9 offset:34816
  s_waitcnt lgkmcnt(4)
  v_mfma_f32_32x32x16_bf16 v[48:63], v[224:227], v[96:99], v[48:63]
  ds_read_b64_tr_b16 v[114:115], v9 offset:35328
  ds_read_b128 v[100:103], v6 offset:0
  s_waitcnt lgkmcnt(4)
  v_mfma_f32_32x32x16_bf16 v[80:95], v[108:111], v[224:227], v[80:95]
  ds_read_b64_tr_b16 v[116:117], v10 offset:34816
  ds_read_b64_tr_b16 v[118:119], v10 offset:35328
  s_add_u32 m0, s75, 20480
  s_add_u32 s77, s13, 114816
  buffer_load_dwordx4 v14, s[28:31], s77 offen lds
  s_waitcnt lgkmcnt(3)
  v_mfma_f32_32x32x16_bf16 v[64:79], v[112:115], v[228:231], v[64:79]
  ds_read_b128 v[232:235], v3 offset:0
  ds_read_b64_tr_b16 v[104:105], v9 offset:36864
  s_waitcnt lgkmcnt(4)
  v_mfma_f32_32x32x16_bf16 v[48:63], v[228:231], v[100:103], v[48:63]
  ds_read_b64_tr_b16 v[106:107], v9 offset:37376
  ds_read_b128 v[96:99], v7 offset:0
  s_waitcnt lgkmcnt(4)
  v_mfma_f32_32x32x16_bf16 v[80:95], v[116:119], v[228:231], v[80:95]
  ds_read_b64_tr_b16 v[108:109], v10 offset:36864
  ds_read_b64_tr_b16 v[110:111], v10 offset:37376
  s_waitcnt lgkmcnt(3)
  v_mfma_f32_32x32x16_bf16 v[64:79], v[104:107], v[232:235], v[64:79]
  ds_read_b128 v[236:239], v4 offset:0
  ds_read_b64_tr_b16 v[112:113], v9 offset:38912
  s_waitcnt lgkmcnt(4)
  v_mfma_f32_32x32x16_bf16 v[48:63], v[232:235], v[96:99], v[48:63]
  ds_read_b64_tr_b16 v[114:115], v9 offset:39424
  ds_read_b128 v[100:103], v8 offset:0
  s_waitcnt lgkmcnt(4)
  v_mfma_f32_32x32x16_bf16 v[80:95], v[108:111], v[232:235], v[80:95]
  ds_read_b64_tr_b16 v[116:117], v10 offset:38912
  ds_read_b64_tr_b16 v[118:119], v10 offset:39424
  s_waitcnt lgkmcnt(3)
  v_mfma_f32_32x32x16_bf16 v[64:79], v[112:115], v[236:239], v[64:79]
  s_waitcnt vmcnt(4)
  s_waitcnt lgkmcnt(0)
  s_barrier
  ds_read_b64_tr_b16 v[240:241], v9 offset:49152
  ds_read_b64_tr_b16 v[242:243], v9 offset:49664
  v_and_b32 v34, 0x1f0, v47
  v_lshrrev_b32 v34, 1, v34
  s_lshl_b32 s56, s54, 8
  s_add_u32 s56, s56, 139264
  v_add_u32 v35, s56, v34
  ds_read_b64 v[36:37], v35
  v_lshrrev_b32 v34, 1, v34
  v_mfma_f32_32x32x16_bf16 v[48:63], v[236:239], v[100:103], v[48:63]
  ds_read_b64_tr_b16 v[244:245], v10 offset:49152
  ds_read_b64_tr_b16 v[246:247], v10 offset:49664
  s_lshl_b32 s56, s54, 7
  s_add_u32 s56, s56, 142592
  v_add_u32 v34, s56, v34
  ds_read_b32 v26, v34
  v_and_b32 v34, 15, v0
  s_lshl_b32 s56, s55, 6
  s_add_u32 s56, s56, 143104
  v_lshlrev_b32 v34, 2, v34
  v_add_u32 v34, s56, v34
  v_mfma_f32_32x32x16_bf16 v[80:95], v[116:119], v[236:239], v[80:95]
  s_add_u32 m0, s75, 32768
  s_add_u32 s77, s14, 128
  buffer_load_dwordx4 v14, s[28:31], s77 offen lds
  s_waitcnt lgkmcnt(4)
  v_mfma_f32_32x32x16_bf16 v[96:111], v[240:243], v[128:131], 0
  ds_read_b64_tr_b16 v[248:249], v9 offset:51200
  ds_read_b64_tr_b16 v[250:251], v9 offset:51712
  ds_read_b32 v28, v34
  ds_read_b32 v29, v34 offset:128
  v_lshrrev_b32 v34, 4, v0
  s_lshl_b32 s56, s54, 8
  s_add_u32 s56, s56, 139264
  v_lshlrev_b32 v34, 6, v34
  v_add_u32 v34, s56, v34
  s_waitcnt lgkmcnt(7)
  v_mov_b32 v25, v36
  v_mul_f32 v27, 0xbfb8aa3b, v37
  ds_read_b128 v[36:39], v34
  ds_read_b128 v[40:43], v34 offset:16
  s_waitcnt lgkmcnt(2)
  v_permlane16_swap_b32 v48, v56
  v_permlane16_swap_b32 v49, v57
  v_permlane16_swap_b32 v50, v58
  v_permlane16_swap_b32 v51, v59
  v_permlane16_swap_b32 v52, v60
  v_permlane16_swap_b32 v53, v61
  v_permlane16_swap_b32 v54, v62
  v_mfma_f32_32x32x16_bf16 v[112:127], v[244:247], v[128:131], 0
  ds_read_b64_tr_b16 v[252:253], v10 offset:51200
  ds_read_b64_tr_b16 v[254:255], v10 offset:51712
  s_add_u32 m0, s75, 36864
  s_add_u32 s77, s14, 114816
  buffer_load_dwordx4 v14, s[28:31], s77 offen lds
  v_lshrrev_b32 v13, 3, v0
  s_lshl_b32 s57, s48, 3
  v_add_u32 v13, s57, v13
  v_mul_u32_u24 v13, 896, v13
  v_and_b32 v11, 7, v0
  v_bfe_u32 v12, v0, 4, 1
  v_lshlrev_b32 v12, 2, v12
  v_xor_b32 v11, v11, v12
  v_lshl_add_u32 v13, v11, 4, v13
  s_mov_b32 s92, s86
  s_and_b32 s93, s87, 0xffff
  s_mov_b32 s94, 1605632
  s_mov_b32 s95, 0x20000
  s_cmp_ge_u32 s53, 7
  s_cselect_b32 s57, 7, 0
  s_sub_u32 s57, s53, s57
  s_and_b32 s70, s51, 3
  s_mul_i32 s70, s70, 7
  s_lshl_b32 s71, s57, 2
  s_add_u32 s70, s70, s71
  s_cmp_ge_u32 s70, 28
  s_cselect_b32 s71, 28, 0
  s_sub_u32 s70, s70, s71
  s_lshl_b32 s71, s57, 7
  s_lshl_b32 s69, s48, 10
  v_mfma_f32_32x32x16_bf16 v[96:111], v[248:251], v[132:135], v[96:111]
  ds_read_b64_tr_b16 v[240:241], v9 offset:53248
  ds_read_b64_tr_b16 v[242:243], v9 offset:53760
  v_permlane16_swap_b32 v55, v63
  s_waitcnt lgkmcnt(5)
  v_fma_f32 v48, -v36, v28, v48
  v_fma_f32 v56, -v36, v29, v56
  v_fma_f32 v49, -v38, v28, v49
  v_fma_f32 v57, -v38, v29, v57
  v_mul_f32 v48, v48, v37
  v_mul_f32 v56, v56, v37
  s_waitcnt lgkmcnt(2)
  v_mfma_f32_32x32x16_bf16 v[112:127], v[252:255], v[132:135], v[112:127]
  ds_read_b64_tr_b16 v[244:245], v10 offset:53248
  ds_read_b64_tr_b16 v[246:247], v10 offset:53760
  v_mul_f32 v49, v49, v39
  v_mul_f32 v57, v57, v39
  ds_read_b128 v[36:39], v34 offset:32
  v_fma_f32 v50, -v40, v28, v50
  v_fma_f32 v58, -v40, v29, v58
  v_fma_f32 v51, -v42, v28, v51
  v_fma_f32 v59, -v42, v29, v59
  v_mul_f32 v50, v50, v41
  s_waitcnt lgkmcnt(3)
  v_mfma_f32_32x32x16_bf16 v[96:111], v[240:243], v[136:139], v[96:111]
  ds_read_b64_tr_b16 v[248:249], v9 offset:55296
  ds_read_b64_tr_b16 v[250:251], v9 offset:55808
  s_add_u32 m0, s69, 0
  s_mul_i32 s68, s70, 57344
  s_add_u32 s68, s68, s71
  buffer_load_dwordx4 v13, s[92:95], s68 offen lds
  s_add_u32 s70, s70, 1
  s_cmp_eq_u32 s70, 28
  s_cselect_b32 s70, 0, s70
  v_mul_f32 v58, v58, v41
  v_mul_f32 v51, v51, v43
  v_mul_f32 v59, v59, v43
  ds_read_b128 v[40:43], v34 offset:48
  s_waitcnt lgkmcnt(3)
  v_fma_f32 v52, -v36, v28, v52
  v_fma_f32 v60, -v36, v29, v60
  v_fma_f32 v53, -v38, v28, v53
  v_fma_f32 v61, -v38, v29, v61
  v_mfma_f32_32x32x16_bf16 v[112:127], v[244:247], v[136:139], v[112:127]
  ds_read_b64_tr_b16 v[252:253], v10 offset:55296
  ds_read_b64_tr_b16 v[254:255], v10 offset:55808
  v_mul_f32 v52, v52, v37
  v_mul_f32 v60, v60, v37
  v_mul_f32 v53, v53, v39
  v_mul_f32 v61, v61, v39
  s_waitcnt lgkmcnt(2)
  v_fma_f32 v54, -v40, v28, v54
  v_fma_f32 v62, -v40, v29, v62
  v_fma_f32 v55, -v42, v28, v55
  v_mfma_f32_32x32x16_bf16 v[96:111], v[248:251], v[140:143], v[96:111]
  s_waitcnt vmcnt(5)
  s_waitcnt lgkmcnt(0)
  s_barrier
  ds_read_b64_tr_b16 v[240:241], v9 offset:0
  ds_read_b64_tr_b16 v[242:243], v9 offset:512
  s_cmp_lg_u32 s48, 4
  s_cbranch_scc1 K1_A2I_11
  s_lshl_b32 s61, s53, 10
  s_add_u32 s61, s61, 11042816
  v_lshlrev_b32 v136, 4, v0
  buffer_load_dwordx4 v[128:131], v136, s[32:35], s61 offen sc1
  s_add_u32 s61, s61, 14336
  buffer_load_dwordx4 v[132:135], v136, s[32:35], s61 offen sc1
K1_A2I_11:
  v_fma_f32 v63, -v42, v29, v63
  v_mul_f32 v54, v54, v41
  v_mul_f32 v62, v62, v41
  v_mul_f32 v55, v55, v43
  v_mul_f32 v63, v63, v43
  v_fma_f32 v44, v15, v48, v49
  v_fma_f32 v45, v15, v56, v57
  v_mfma_f32_32x32x16_bf16 v[112:127], v[252:255], v[140:143], v[112:127]
  ds_read_b64_tr_b16 v[244:245], v10 offset:0
  ds_read_b64_tr_b16 v[246:247], v10 offset:512
  s_add_u32 m0, s75, 49152
  s_add_u32 s77, s15, 128
  buffer_load_dwordx4 v14, s[28:31], s77 offen lds
  s_waitcnt lgkmcnt(2)
  v_mfma_f32_32x32x16_bf16 v[96:111], v[240:243], v[144:147], v[96:111]
  ds_read_b64_tr_b16 v[248:249], v9 offset:2048
  ds_read_b64_tr_b16 v[250:251], v9 offset:2560
  v_fma_f32 v44, -v16, v56, v44
  v_fma_f32 v45, v16, v48, v45
  v_fma_f32 v32, v15, v44, v50
  v_fma_f32 v33, v15, v45, v58
  v_fma_f32 v32, -v16, v45, v32
  v_fma_f32 v33, v16, v44, v33
  v_fma_f32 v44, v15, v32, v51
  s_waitcnt lgkmcnt(2)
  v_mfma_f32_32x32x16_bf16 v[112:127], v[244:247], v[144:147], v[112:127]
  ds_read_b64_tr_b16 v[252:253], v10 offset:2048
  ds_read_b64_tr_b16 v[254:255], v10 offset:2560
  s_add_u32 m0, s75, 53248
  s_add_u32 s77, s15, 114816
  buffer_load_dwordx4 v14, s[28:31], s77 offen lds
  s_waitcnt lgkmcnt(2)
  v_mfma_f32_32x32x16_bf16 v[96:111], v[248:251], v[148:151], v[96:111]
  ds_read_b64_tr_b16 v[240:241], v9 offset:4096
  ds_read_b64_tr_b16 v[242:243], v9 offset:4608
  s_add_u32 m0, s69, 8192
  s_mul_i32 s68, s70, 57344
  s_add_u32 s68, s68, s71
  buffer_load_dwordx4 v13, s[92:95], s68 offen lds
  s_add_u32 s70, s70, 1
  s_cmp_eq_u32 s70, 28
  s_cselect_b32 s70, 0, s70
  v_fma_f32 v45, v15, v33, v59
  v_fma_f32 v44, -v16, v33, v44
  v_fma_f32 v45, v16, v32, v45
  v_fma_f32 v32, v15, v44, v52
  v_fma_f32 v33, v15, v45, v60
  v_fma_f32 v32, -v16, v45, v32
  v_fma_f32 v33, v16, v44, v33
  s_waitcnt lgkmcnt(2)
  v_mfma_f32_32x32x16_bf16 v[112:127], v[252:255], v[148:151], v[112:127]
  ds_read_b64_tr_b16 v[244:245], v10 offset:4096
  ds_read_b64_tr_b16 v[246:247], v10 offset:4608
  v_fma_f32 v44, v15, v32, v53
  v_fma_f32 v45, v15, v33, v61
  v_fma_f32 v44, -v16, v33, v44
  v_fma_f32 v45, v16, v32, v45
  v_fma_f32 v32, v15, v44, v54
  v_fma_f32 v33, v15, v45, v62
  v_fma_f32 v32, -v16, v45, v32
  s_waitcnt lgkmcnt(2)
  v_mfma_f32_32x32x16_bf16 v[96:111], v[240:243], v[152:155], v[96:111]
  ds_read_b64_tr_b16 v[248:249], v9 offset:6144
  ds_read_b64_tr_b16 v[250:251], v9 offset:6656
  v_fma_f32 v33, v16, v44, v33
  v_fma_f32 v44, v15, v32, v55
  v_fma_f32 v45, v15, v33, v63
  v_fma_f32 v44, -v16, v33, v44
  v_fma_f32 v45, v16, v32, v45
  v_mul_f32 v36, v18, v45
  v_mul_f32 v37, v18, v44
  s_waitcnt lgkmcnt(2)
  v_mfma_f32_32x32x16_bf16 v[112:127], v[244:247], v[152:155], v[112:127]
  ds_read_b64_tr_b16 v[252:253], v10 offset:6144
  ds_read_b64_tr_b16 v[254:255], v10 offset:6656
  v_fma_f32 v32, v17, v44, -v36
  v_fma_f32 v33, v17, v45, v37
  v_mov_b32 v1, v32
  v_mov_b32 v2, v32
  v_mov_b32 v3, v33
  v_mov_b32 v4, v33
  v_mul_f32 v34, v20, v20
  s_waitcnt lgkmcnt(2)
  v_mfma_f32_32x32x16_bf16 v[96:111], v[248:251], v[156:159], v[96:111]
  s_waitcnt vmcnt(6)
  s_waitcnt lgkmcnt(0)
  s_barrier
  ds_read_b64_tr_b16 v[240:241], v9 offset:16384
  ds_read_b64_tr_b16 v[242:243], v9 offset:16896
  v_mul_f32 v35, v19, v20
  v_fma_f32 v7, v19, v19, -v34
  v_add_f32 v8, v35, v35
  v_permlane16_swap_b32 v1, v2
  v_permlane16_swap_b32 v3, v4
  v_fma_f32 v5, v19, v1, v2
  v_fma_f32 v6, v19, v3, v4
  v_mfma_f32_32x32x16_bf16 v[112:127], v[252:255], v[156:159], v[112:127]
  ds_read_b64_tr_b16 v[244:245], v10 offset:16384
  ds_read_b64_tr_b16 v[246:247], v10 offset:16896
  s_add_u32 m0, s75, 0
  s_add_u32 s77, s16, 128
  buffer_load_dwordx4 v14, s[28:31], s77 offen lds
  s_waitcnt lgkmcnt(2)
  v_mfma_f32_32x32x16_bf16 v[96:111], v[240:243], v[160:163], v[96:111]
  ds_read_b64_tr_b16 v[248:249], v9 offset:18432
  ds_read_b64_tr_b16 v[250:251], v9 offset:18944
  s_add_u32 m0, s69, 16384
  s_mul_i32 s68, s70, 57344
  s_add_u32 s68, s68, s71
  buffer_load_dwordx4 v13, s[92:95], s68 offen lds
  s_add_u32 s70, s70, 1
  s_cmp_eq_u32 s70, 28
  s_cselect_b32 s70, 0, s70
  v_fma_f32 v5, -v20, v3, v5
  v_fma_f32 v6, v20, v1, v6
  v_mov_b32 v28, v5
  v_mov_b32 v36, v5
  v_mov_b32 v29, v6
  v_mov_b32 v34, v6
  v_and_b32 v35, 15, v0
  s_waitcnt lgkmcnt(2)
  v_mfma_f32_32x32x16_bf16 v[112:127], v[244:247], v[160:163], v[112:127]
  ds_read_b64_tr_b16 v[252:253], v10 offset:18432
  ds_read_b64_tr_b16 v[254:255], v10 offset:18944
  s_add_u32 m0, s75, 4096
  s_add_u32 s77, s16, 114816
  buffer_load_dwordx4 v14, s[28:31], s77 offen lds
  s_waitcnt lgkmcnt(2)
  v_mfma_f32_32x32x16_bf16 v[96:111], v[248:251], v[164:167], v[96:111]
  ds_read_b64_tr_b16 v[240:241], v9 offset:20480
  ds_read_b64_tr_b16 v[242:243], v9 offset:20992
  s_lshl_b32 s56, s55, 4
  v_add_u32 v35, s56, v35
  v_lshlrev_b32 v35, 3, v35
  v_permlane32_swap_b32 v28, v36
  v_permlane32_swap_b32 v29, v34
  v_add_u32 v35, 141312, v35
  v_fma_f32 v5, v7, v28, v36
  v_fma_f32 v6, v7, v29, v34
  s_waitcnt lgkmcnt(2)
  v_mfma_f32_32x32x16_bf16 v[112:127], v[252:255], v[164:167], v[112:127]
  ds_read_b64_tr_b16 v[244:245], v10 offset:20480
  ds_read_b64_tr_b16 v[246:247], v10 offset:20992
  v_fma_f32 v5, -v8, v29, v5
  v_fma_f32 v6, v8, v28, v6
  s_lshl_b32 s56, s54, 8
  v_add_u32 v34, s56, v35
  v_mov_b32 v44, v5
  v_mov_b32 v45, v6
  ds_write_b64 v34, v[44:45]
  s_waitcnt lgkmcnt(3)
  v_mfma_f32_32x32x16_bf16 v[96:111], v[240:243], v[168:171], v[96:111]
  ds_read_b64_tr_b16 v[248:249], v9 offset:22528
  ds_read_b64_tr_b16 v[250:251], v9 offset:23040
  s_waitcnt lgkmcnt(3)
  v_mfma_f32_32x32x16_bf16 v[112:127], v[244:247], v[168:171], v[112:127]
  ds_read_b64_tr_b16 v[252:253], v10 offset:22528
  ds_read_b64_tr_b16 v[254:255], v10 offset:23040
  s_waitcnt lgkmcnt(2)
  v_mfma_f32_32x32x16_bf16 v[96:111], v[248:251], v[172:175], v[96:111]
  s_waitcnt vmcnt(7)
  s_waitcnt lgkmcnt(0)
  s_barrier
  ds_read_b64_tr_b16 v[240:241], v9 offset:32768
  ds_read_b64_tr_b16 v[242:243], v9 offset:33280
  s_add_u32 m0, s69, 24576
  s_mul_i32 s68, s70, 57344
  s_add_u32 s68, s68, s71
  buffer_load_dwordx4 v13, s[92:95], s68 offen lds
  s_add_u32 s70, s70, 1
  s_cmp_eq_u32 s70, 28
  s_cselect_b32 s70, 0, s70
  ds_read_b64 v[36:37], v35 offset:0
  ds_read_b64 v[38:39], v35 offset:256
  ds_read_b64 v[40:41], v35 offset:512
  v_mul_f32 v44, v8, v8
  v_mul_f32 v45, v7, v8
  v_fma_f32 v42, v7, v7, -v44
  v_add_f32 v43, v45, v45
  s_waitcnt lgkmcnt(0)
  v_fma_f32 v44, v42, v36, v38
  v_fma_f32 v45, v42, v37, v39
  v_mfma_f32_32x32x16_bf16 v[112:127], v[252:255], v[172:175], v[112:127]
  ds_read_b64_tr_b16 v[244:245], v10 offset:32768
  ds_read_b64_tr_b16 v[246:247], v10 offset:33280
  s_add_u32 m0, s75, 16384
  s_add_u32 s77, s17, 128
  buffer_load_dwordx4 v14, s[28:31], s77 offen lds
  v_mfma_f32_32x32x16_bf16 v[96:111], v[240:243], v[176:179], v[96:111]
  ds_read_b64_tr_b16 v[248:249], v9 offset:34816
  ds_read_b64_tr_b16 v[250:251], v9 offset:35328
  v_fma_f32 v44, -v43, v37, v44
  v_fma_f32 v45, v43, v36, v45
  v_fma_f32 v2, v42, v44, v40
  v_fma_f32 v4, v42, v45, v41
  v_fma_f32 v2, -v43, v45, v2
  v_fma_f32 v4, v43, v44, v4
  v_cndmask_b32 v2, v44, v2, s[40:41]
  s_waitcnt lgkmcnt(2)
  v_mfma_f32_32x32x16_bf16 v[112:127], v[244:247], v[176:179], v[112:127]
  ds_read_b64_tr_b16 v[252:253], v10 offset:34816
  ds_read_b64_tr_b16 v[254:255], v10 offset:35328
  s_add_u32 m0, s75, 20480
  s_add_u32 s77, s17, 114816
  buffer_load_dwordx4 v14, s[28:31], s77 offen lds
  s_waitcnt lgkmcnt(2)
  v_mfma_f32_32x32x16_bf16 v[96:111], v[248:251], v[180:183], v[96:111]
  ds_read_b64_tr_b16 v[240:241], v9 offset:36864
  ds_read_b64_tr_b16 v[242:243], v9 offset:37376
  s_cmp_lg_u32 s48, 4
  s_cbranch_scc1 K1_A2F_12
  s_waitcnt vmcnt(9)
  v_xor_b32 v137, s98, v129
  v_xor_b32 v138, s98, v131
  v_or_b32 v137, v137, v138
  v_xor_b32 v138, s98, v133
  v_or_b32 v137, v137, v138
  v_xor_b32 v138, s98, v135
  v_or_b32 v137, v137, v138
  v_cmp_ne_u32 vcc, 0, v137
  s_nop 1
  s_cmp_eq_u64 vcc, 0
  s_cbranch_scc1 K1_A2_OK_13
  s_mov_b32 s63, 0
K1_A2_RT_14:
  s_lshl_b32 s61, s53, 10
  s_add_u32 s61, s61, 11042816
  v_lshlrev_b32 v136, 4, v0
  buffer_load_dwordx4 v[128:131], v136, s[32:35], s61 offen sc1
  s_add_u32 s61, s61, 14336
  buffer_load_dwordx4 v[132:135], v136, s[32:35], s61 offen sc1
  s_waitcnt vmcnt(0)
  v_xor_b32 v137, s98, v129
  v_xor_b32 v138, s98, v131
  v_or_b32 v137, v137, v138
  v_xor_b32 v138, s98, v133
  v_or_b32 v137, v137, v138
  v_xor_b32 v138, s98, v135
  v_or_b32 v137, v137, v138
  v_cmp_ne_u32 vcc, 0, v137
  s_nop 1
  s_cmp_eq_u64 vcc, 0
  s_cbranch_scc1 K1_A2_OK_13
  s_add_u32 s63, s63, 1
  s_cmp_lt_u32 s63, 100000
  s_cbranch_scc1 K1_A2_RT_14
K1_A2_OK_13:
  v_mov_b32 v129, v130
  v_mov_b32 v133, v134
  v_lshlrev_b32 v136, 3, v0
  v_add_u32 v136, 140288, v136
  ds_write_b64 v136, v[128:129]
  ds_write_b64 v136, v[132:133] offset:512
  s_waitcnt lgkmcnt(0)
K1_A2F_12:
  v_cndmask_b32 v4, v45, v4, s[40:41]
  v_cndmask_b32 v36, 0, v36, s[40:41]
  v_cndmask_b32 v37, 0, v37, s[40:41]
  v_cndmask_b32 v36, v36, v2, s[42:43]
  v_cndmask_b32 v37, v37, v4, s[42:43]
  s_cmp_lg_u32 s54, 3
  s_cbranch_scc1 K1_NOPUB_15
  v_fma_f32 v38, v42, v36, v5
  v_fma_f32 v40, v42, v37, v6
  v_fma_f32 v38, -v43, v37, v38
  v_fma_f32 v40, v43, v36, v40
  v_mov_b32 v39, s98
  v_mov_b32 v41, s98
  v_and_b32 v34, 15, v0
  v_add_u32 v34, s78, v34
  v_lshlrev_b32 v34, 4, v34
  s_mul_i32 s56, s52, 7168
  s_add_u32 s56, s56, 11078656
  s_mov_b64 s[58:59], exec
  s_mov_b64 exec, 0xffff
  buffer_store_dwordx4 v[38:41], v34, s[32:35], s56 offen sc1
  s_mov_b64 exec, s[58:59]
K1_NOPUB_15:
  s_waitcnt lgkmcnt(2)
  v_mfma_f32_32x32x16_bf16 v[112:127], v[252:255], v[180:183], v[112:127]
  ds_read_b64_tr_b16 v[244:245], v10 offset:36864
  ds_read_b64_tr_b16 v[246:247], v10 offset:37376
  v_fma_f32 v38, v7, v36, v28
  v_fma_f32 v39, v7, v37, v29
  v_fma_f32 v38, -v8, v37, v38
  v_fma_f32 v39, v8, v36, v39
  v_cndmask_b32 v36, v36, v38, s[46:47]
  v_cndmask_b32 v37, v37, v39, s[46:47]
  v_fma_f32 v38, v19, v36, v1
  s_waitcnt lgkmcnt(2)
  v_mfma_f32_32x32x16_bf16 v[96:111], v[240:243], v[184:187], v[96:111]
  ds_read_b64_tr_b16 v[248:249], v9 offset:38912
  ds_read_b64_tr_b16 v[250:251], v9 offset:39424
  s_add_u32 m0, s69, 32768
  s_mul_i32 s68, s70, 57344
  s_add_u32 s68, s68, s71
  buffer_load_dwordx4 v13, s[92:95], s68 offen lds
  s_add_u32 s70, s70, 1
  s_cmp_eq_u32 s70, 28
  s_cselect_b32 s70, 0, s70
  v_fma_f32 v39, v19, v37, v3
  v_fma_f32 v38, -v20, v37, v38
  v_fma_f32 v39, v20, v36, v39
  v_cndmask_b32 v30, v36, v38, s[44:45]
  v_cndmask_b32 v31, v37, v39, s[44:45]
  v_mul_f32 v36, v18, v56
  v_mul_f32 v37, v18, v48
  s_waitcnt lgkmcnt(2)
  v_mfma_f32_32x32x16_bf16 v[112:127], v[244:247], v[184:187], v[112:127]
  ds_read_b64_tr_b16 v[252:253], v10 offset:38912
  ds_read_b64_tr_b16 v[254:255], v10 offset:39424
  v_mul_f32 v38, v18, v57
  v_mul_f32 v39, v18, v49
  v_fma_f32 v48, v17, v48, -v36
  v_fma_f32 v56, v17, v56, v37
  v_fma_f32 v49, v17, v49, -v38
  v_fma_f32 v57, v17, v57, v39
  v_mul_f32 v36, v18, v58
  s_waitcnt lgkmcnt(2)
  v_mfma_f32_32x32x16_bf16 v[96:111], v[248:251], v[188:191], v[96:111]
  s_waitcnt vmcnt(8)
  s_waitcnt lgkmcnt(0)
  s_barrier
  ds_read_b64_tr_b16 v[240:241], v9 offset:49152
  ds_read_b64_tr_b16 v[242:243], v9 offset:49664
  v_mul_f32 v37, v18, v50
  v_mul_f32 v38, v18, v59
  v_mul_f32 v39, v18, v51
  v_fma_f32 v50, v17, v50, -v36
  v_fma_f32 v58, v17, v58, v37
  v_fma_f32 v51, v17, v51, -v38
  v_mfma_f32_32x32x16_bf16 v[112:127], v[252:255], v[188:191], v[112:127]
  ds_read_b64_tr_b16 v[244:245], v10 offset:49152
  ds_read_b64_tr_b16 v[246:247], v10 offset:49664
  v_fma_f32 v59, v17, v59, v39
  v_mul_f32 v36, v18, v60
  v_mul_f32 v37, v18, v52
  v_mul_f32 v38, v18, v61
  v_mul_f32 v39, v18, v53
  v_fma_f32 v52, v17, v52, -v36
  s_waitcnt lgkmcnt(2)
  v_mfma_f32_32x32x16_bf16 v[96:111], v[240:243], v[192:195], v[96:111]
  ds_read_b64_tr_b16 v[248:249], v9 offset:51200
  ds_read_b64_tr_b16 v[250:251], v9 offset:51712
  v_fma_f32 v60, v17, v60, v37
  v_fma_f32 v53, v17, v53, -v38
  v_fma_f32 v61, v17, v61, v39
  v_mul_f32 v36, v18, v62
  v_mul_f32 v37, v18, v54
  v_mul_f32 v38, v18, v63
  s_waitcnt lgkmcnt(2)
  v_mfma_f32_32x32x16_bf16 v[112:127], v[244:247], v[192:195], v[112:127]
  ds_read_b64_tr_b16 v[252:253], v10 offset:51200
  ds_read_b64_tr_b16 v[254:255], v10 offset:51712
  v_mul_f32 v39, v18, v55
  v_fma_f32 v54, v17, v54, -v36
  v_fma_f32 v62, v17, v62, v37
  v_fma_f32 v55, v17, v55, -v38
  v_fma_f32 v63, v17, v63, v39
  v_lshrrev_b32 v46, 5, v0
  s_waitcnt lgkmcnt(2)
  v_mfma_f32_32x32x16_bf16 v[96:111], v[248:251], v[196:199], v[96:111]
  ds_read_b64_tr_b16 v[240:241], v9 offset:53248
  ds_read_b64_tr_b16 v[242:243], v9 offset:53760
  s_add_u32 m0, s69, 40960
  s_mul_i32 s68, s70, 57344
  s_add_u32 s68, s68, s71
  buffer_load_dwordx4 v13, s[92:95], s68 offen lds
  s_add_u32 s70, s70, 1
  s_cmp_eq_u32 s70, 28
  s_cselect_b32 s70, 0, s70
  v_lshlrev_b32 v46, 4, v46
  s_lshl_b32 s56, s55, 7
  s_add_u32 s56, s56, 140288
  v_add_u32 v46, s56, v46
  ds_read_b128 v[128:131], v46 offset:0
  ds_read_b128 v[132:135], v46 offset:32
  ds_read_b128 v[136:139], v46 offset:512
  ds_read_b128 v[140:143], v46 offset:544
  ds_read_b128 v[144:147], v46 offset:64
  ds_read_b128 v[148:151], v46 offset:96
  ds_read_b128 v[152:155], v46 offset:576
  ds_read_b128 v[156:159], v46 offset:608
  s_waitcnt lgkmcnt(10)
  v_mfma_f32_32x32x16_bf16 v[112:127], v[252:255], v[196:199], v[112:127]
  ds_read_b64_tr_b16 v[244:245], v10 offset:53248
  ds_read_b64_tr_b16 v[246:247], v10 offset:53760
  s_waitcnt lgkmcnt(6)
  v_fma_f32 v64, -v25, v128, v64
  v_fma_f32 v65, -v25, v129, v65
  v_fma_f32 v66, -v25, v130, v66
  v_fma_f32 v67, -v25, v131, v67
  v_fma_f32 v68, -v25, v132, v68
  v_fma_f32 v69, -v25, v133, v69
  v_mfma_f32_32x32x16_bf16 v[96:111], v[240:243], v[200:203], v[96:111]
  ds_read_b64_tr_b16 v[248:249], v9 offset:55296
  ds_read_b64_tr_b16 v[250:251], v9 offset:55808
  v_fma_f32 v70, -v25, v134, v70
  v_fma_f32 v71, -v25, v135, v71
  v_mul_f32 v64, v64, v27
  v_mul_f32 v65, v65, v27
  v_mul_f32 v66, v66, v27
  v_mul_f32 v67, v67, v27
  s_waitcnt lgkmcnt(2)
  v_mfma_f32_32x32x16_bf16 v[112:127], v[244:247], v[200:203], v[112:127]
  ds_read_b64_tr_b16 v[252:253], v10 offset:55296
  ds_read_b64_tr_b16 v[254:255], v10 offset:55808
  v_mul_f32 v68, v68, v27
  v_mul_f32 v69, v69, v27
  v_mul_f32 v70, v70, v27
  v_mul_f32 v71, v71, v27
  v_exp_f32 v64, v64
  s_waitcnt lgkmcnt(2)
  v_mfma_f32_32x32x16_bf16 v[96:111], v[248:251], v[204:207], v[96:111]
  s_waitcnt vmcnt(5)
  s_waitcnt lgkmcnt(0)
  s_barrier
  ds_read_b64_tr_b16 v[240:241], v9 offset:0
  ds_read_b64_tr_b16 v[242:243], v9 offset:512
  v_fma_f32 v72, -v25, v136, v72
  v_exp_f32 v65, v65
  v_fma_f32 v73, -v25, v137, v73
  v_exp_f32 v66, v66
  v_mfma_f32_32x32x16_bf16 v[112:127], v[252:255], v[204:207], v[112:127]
  ds_read_b64_tr_b16 v[244:245], v10 offset:0
  ds_read_b64_tr_b16 v[246:247], v10 offset:512
  v_fma_f32 v74, -v25, v138, v74
  v_exp_f32 v67, v67
  v_fma_f32 v75, -v25, v139, v75
  v_exp_f32 v68, v68
  s_waitcnt lgkmcnt(2)
  v_mfma_f32_32x32x16_bf16 v[96:111], v[240:243], v[208:211], v[96:111]
  ds_read_b64_tr_b16 v[248:249], v9 offset:2048
  ds_read_b64_tr_b16 v[250:251], v9 offset:2560
  s_add_u32 m0, s69, 49152
  s_mul_i32 s68, s70, 57344
  s_add_u32 s68, s68, s71
  buffer_load_dwordx4 v13, s[92:95], s68 offen lds
  s_add_u32 s70, s70, 1
  s_cmp_eq_u32 s70, 28
  s_cselect_b32 s70, 0, s70
  v_fma_f32 v76, -v25, v140, v76
  v_exp_f32 v69, v69
  v_fma_f32 v77, -v25, v141, v77
  v_exp_f32 v70, v70
  s_waitcnt lgkmcnt(2)
  v_mfma_f32_32x32x16_bf16 v[112:127], v[244:247], v[208:211], v[112:127]
  ds_read_b64_tr_b16 v[252:253], v10 offset:2048
  ds_read_b64_tr_b16 v[254:255], v10 offset:2560
  v_fma_f32 v78, -v25, v142, v78
  v_exp_f32 v71, v71
  v_fma_f32 v79, -v25, v143, v79
  v_fma_f32 v64, v64, v26, v26
  v_fma_f32 v65, v65, v26, v26
  s_waitcnt lgkmcnt(2)
  v_mfma_f32_32x32x16_bf16 v[96:111], v[248:251], v[212:215], v[96:111]
  ds_read_b64_tr_b16 v[240:241], v9 offset:4096
  ds_read_b64_tr_b16 v[242:243], v9 offset:4608
  v_fma_f32 v66, v66, v26, v26
  v_fma_f32 v67, v67, v26, v26
  v_fma_f32 v68, v68, v26, v26
  v_fma_f32 v69, v69, v26, v26
  v_fma_f32 v70, v70, v26, v26
  v_fma_f32 v71, v71, v26, v26
  s_waitcnt lgkmcnt(2)
  v_mfma_f32_32x32x16_bf16 v[112:127], v[252:255], v[212:215], v[112:127]
  ds_read_b64_tr_b16 v[244:245], v10 offset:4096
  ds_read_b64_tr_b16 v[246:247], v10 offset:4608
  v_rcp_f32 v64, v64
  v_rcp_f32 v65, v65
  v_rcp_f32 v66, v66
  s_waitcnt lgkmcnt(2)
  v_mfma_f32_32x32x16_bf16 v[96:111], v[240:243], v[216:219], v[96:111]
  ds_read_b64_tr_b16 v[248:249], v9 offset:6144
  ds_read_b64_tr_b16 v[250:251], v9 offset:6656
  v_rcp_f32 v67, v67
  v_rcp_f32 v68, v68
  v_rcp_f32 v69, v69
  s_waitcnt lgkmcnt(2)
  v_mfma_f32_32x32x16_bf16 v[112:127], v[244:247], v[216:219], v[112:127]
  ds_read_b64_tr_b16 v[252:253], v10 offset:6144
  ds_read_b64_tr_b16 v[254:255], v10 offset:6656
  v_rcp_f32 v70, v70
  v_rcp_f32 v71, v71
  v_mul_f32 v64, v64, v72
  v_mul_f32 v65, v65, v73
  s_waitcnt lgkmcnt(2)
  v_mfma_f32_32x32x16_bf16 v[96:111], v[248:251], v[220:223], v[96:111]
  s_waitcnt vmcnt(3)
  s_waitcnt lgkmcnt(0)
  s_barrier
  ds_read_b64_tr_b16 v[240:241], v9 offset:16384
  ds_read_b64_tr_b16 v[242:243], v9 offset:16896
  s_add_u32 m0, s69, 57344
  s_mul_i32 s68, s70, 57344
  s_add_u32 s68, s68, s71
  buffer_load_dwordx4 v13, s[92:95], s68 offen lds
  s_add_u32 s70, s70, 1
  s_cmp_eq_u32 s70, 28
  s_cselect_b32 s70, 0, s70
  v_mul_f32 v66, v66, v74
  v_mul_f32 v67, v67, v75
  v_mul_f32 v68, v68, v76
  v_mul_f32 v69, v69, v77
  v_mul_f32 v70, v70, v78
  v_mul_f32 v71, v71, v79
  v_mfma_f32_32x32x16_bf16 v[112:127], v[252:255], v[220:223], v[112:127]
  ds_read_b64_tr_b16 v[244:245], v10 offset:16384
  ds_read_b64_tr_b16 v[246:247], v10 offset:16896
  v_cvt_pk_bf16_f32 v72, v64, v65
  v_cvt_pk_bf16_f32 v73, v66, v67
  v_cvt_pk_bf16_f32 v74, v68, v69
  v_cvt_pk_bf16_f32 v75, v70, v71
  s_add_u32 s56, s79, 0
  buffer_store_dwordx4 v[72:75], v47, s[32:35], s56 offen sc1
  ds_read_b128 v[128:131], v46 offset:256
  ds_read_b128 v[132:135], v46 offset:288
  ds_read_b128 v[136:139], v46 offset:768
  ds_read_b128 v[140:143], v46 offset:800
  s_waitcnt lgkmcnt(6)
  v_mfma_f32_32x32x16_bf16 v[96:111], v[240:243], v[224:227], v[96:111]
  ds_read_b64_tr_b16 v[248:249], v9 offset:18432
  ds_read_b64_tr_b16 v[250:251], v9 offset:18944
  v_fma_f32 v80, -v25, v144, v80
  v_fma_f32 v81, -v25, v145, v81
  v_fma_f32 v82, -v25, v146, v82
  v_fma_f32 v83, -v25, v147, v83
  v_fma_f32 v84, -v25, v148, v84
  v_fma_f32 v85, -v25, v149, v85
  s_waitcnt lgkmcnt(6)
  v_mfma_f32_32x32x16_bf16 v[112:127], v[244:247], v[224:227], v[112:127]
  ds_read_b64_tr_b16 v[252:253], v10 offset:18432
  ds_read_b64_tr_b16 v[254:255], v10 offset:18944
  v_fma_f32 v86, -v25, v150, v86
  v_fma_f32 v87, -v25, v151, v87
  v_mul_f32 v80, v80, v27
  v_mul_f32 v81, v81, v27
  v_mul_f32 v82, v82, v27
  v_mul_f32 v83, v83, v27
  s_waitcnt lgkmcnt(2)
  v_mfma_f32_32x32x16_bf16 v[96:111], v[248:251], v[228:231], v[96:111]
  ds_read_b64_tr_b16 v[240:241], v9 offset:20480
  ds_read_b64_tr_b16 v[242:243], v9 offset:20992
  v_mul_f32 v84, v84, v27
  v_mul_f32 v85, v85, v27
  v_mul_f32 v86, v86, v27
  v_mul_f32 v87, v87, v27
  v_exp_f32 v80, v80
  s_waitcnt lgkmcnt(2)
  v_mfma_f32_32x32x16_bf16 v[112:127], v[252:255], v[228:231], v[112:127]
  ds_read_b64_tr_b16 v[244:245], v10 offset:20480
  ds_read_b64_tr_b16 v[246:247], v10 offset:20992
  v_fma_f32 v88, -v25, v152, v88
  v_exp_f32 v81, v81
  v_fma_f32 v89, -v25, v153, v89
  v_exp_f32 v82, v82
  s_waitcnt lgkmcnt(2)
  v_mfma_f32_32x32x16_bf16 v[96:111], v[240:243], v[232:235], v[96:111]
  ds_read_b64_tr_b16 v[248:249], v9 offset:22528
  ds_read_b64_tr_b16 v[250:251], v9 offset:23040
  s_add_u32 m0, s69, 65536
  s_mul_i32 s68, s70, 57344
  s_add_u32 s68, s68, s71
  buffer_load_dwordx4 v13, s[92:95], s68 offen lds
  s_add_u32 s70, s70, 1
  s_cmp_eq_u32 s70, 28
  s_cselect_b32 s70, 0, s70
  v_fma_f32 v90, -v25, v154, v90
  v_exp_f32 v83, v83
  v_fma_f32 v91, -v25, v155, v91
  v_exp_f32 v84, v84
  s_waitcnt lgkmcnt(2)
  v_mfma_f32_32x32x16_bf16 v[112:127], v[244:247], v[232:235], v[112:127]
  ds_read_b64_tr_b16 v[252:253], v10 offset:22528
  ds_read_b64_tr_b16 v[254:255], v10 offset:23040
  v_fma_f32 v92, -v25, v156, v92
  v_exp_f32 v85, v85
  v_fma_f32 v93, -v25, v157, v93
  v_exp_f32 v86, v86
  s_waitcnt lgkmcnt(2)
  v_mfma_f32_32x32x16_bf16 v[96:111], v[248:251], v[236:239], v[96:111]
  v_fma_f32 v94, -v25, v158, v94
  v_exp_f32 v87, v87
  v_fma_f32 v95, -v25, v159, v95
  v_fma_f32 v80, v80, v26, v26
  v_fma_f32 v81, v81, v26, v26
  s_waitcnt lgkmcnt(0)
  v_mfma_f32_32x32x16_bf16 v[112:127], v[252:255], v[236:239], v[112:127]
  v_fma_f32 v82, v82, v26, v26
  v_fma_f32 v83, v83, v26, v26
  v_fma_f32 v84, v84, v26, v26
  v_fma_f32 v85, v85, v26, v26
  v_fma_f32 v86, v86, v26, v26
  v_fma_f32 v87, v87, v26, v26
  s_cmp_eq_u32 s52, 0
  s_cbranch_scc1 K1_EI_16
  v_lshrrev_b32 v180, 4, v0
  v_and_b32 v181, 15, v0
  v_add_u32 v181, s78, v181
  v_lshlrev_b32 v181, 4, v181
  s_sub_u32 s63, s52, 1
  s_mov_b32 s61, 11078656
  v_add_u32 v176, 0, v180
  v_min_u32 v176, s63, v176
  v_mul_u32_u24 v176, 7168, v176
  v_add_u32 v176, v176, v181
  buffer_load_dwordx4 v[160:163], v176, s[32:35], s61 offen sc1
  v_add_u32 v177, 4, v180
  v_min_u32 v177, s63, v177
  v_mul_u32_u24 v177, 7168, v177
  v_add_u32 v177, v177, v181
  buffer_load_dwordx4 v[164:167], v177, s[32:35], s61 offen sc1
  v_add_u32 v178, 8, v180
  v_min_u32 v178, s63, v178
  v_mul_u32_u24 v178, 7168, v178
  v_add_u32 v178, v178, v181
  buffer_load_dwordx4 v[168:171], v178, s[32:35], s61 offen sc1
  v_add_u32 v179, 12, v180
  v_min_u32 v179, s63, v179
  v_mul_u32_u24 v179, 7168, v179
  v_add_u32 v179, v179, v181
  buffer_load_dwordx4 v[172:175], v179, s[32:35], s61 offen sc1
K1_EI_16:
  s_waitcnt lgkmcnt(0)
  s_barrier
  v_rcp_f32 v80, v80
  v_rcp_f32 v81, v81
  v_rcp_f32 v82, v82
  v_rcp_f32 v83, v83
  v_rcp_f32 v84, v84
  v_rcp_f32 v85, v85
  v_rcp_f32 v86, v86
  v_rcp_f32 v87, v87
  v_mul_f32 v80, v80, v88
  v_mul_f32 v81, v81, v89
  v_mul_f32 v82, v82, v90
  v_mul_f32 v83, v83, v91
  v_mul_f32 v84, v84, v92
  v_mul_f32 v85, v85, v93
  v_mul_f32 v86, v86, v94
  v_mul_f32 v87, v87, v95
  v_cvt_pk_bf16_f32 v88, v80, v81
  v_cvt_pk_bf16_f32 v89, v82, v83
  v_cvt_pk_bf16_f32 v90, v84, v85
  v_cvt_pk_bf16_f32 v91, v86, v87
  s_add_u32 s56, s79, 1024
  buffer_store_dwordx4 v[88:91], v47, s[32:35], s56 offen sc1
  ds_read_b128 v[144:147], v46 offset:320
  ds_read_b128 v[148:151], v46 offset:352
  ds_read_b128 v[152:155], v46 offset:832
  ds_read_b128 v[156:159], v46 offset:864
  s_lshl_b32 s56, s48, 11
  s_add_u32 s56, s56, 145920
  v_and_b32 v1, 15, v0
  v_lshlrev_b32 v1, 6, v1
  v_lshrrev_b32 v2, 4, v0
  v_lshl_add_u32 v1, v2, 4, v1
  v_add_u32 v1, s56, v1
  v_lshrrev_b32 v2, 5, v0
  v_bfe_u32 v3, v0, 2, 2
  v_lshl_add_u32 v2, v2, 3, v3
  v_lshlrev_b32 v2, 6, v2
  v_bfe_u32 v3, v0, 4, 1
  v_lshl_add_u32 v2, v3, 5, v2
  v_and_b32 v3, 3, v0
  v_lshl_add_u32 v2, v3, 3, v2
  v_add_u32 v2, s56, v2
  v_lshlrev_b32 v3, 4, v0
  s_lshl_b32 s56, s53, 1
  s_add_u32 s56, s56, s55
  s_lshr_b32 s57, s56, 2
  s_lshl_b32 s57, s57, 3
  s_and_b32 s56, s56, 3
  s_add_u32 s56, s56, s57
  s_lshl_b32 s57, s52, 2
  s_add_u32 s57, s57, s54
  s_mul_i32 s57, s57, 56
  s_add_u32 s56, s56, s57
  s_lshl_b32 s56, s56, 10
  s_add_u32 s76, s56, 7340032
  v_fma_f32 v96, -v25, v128, v96
  v_fma_f32 v97, -v25, v129, v97
  v_fma_f32 v98, -v25, v130, v98
  v_fma_f32 v99, -v25, v131, v99
  v_fma_f32 v100, -v25, v132, v100
  v_fma_f32 v101, -v25, v133, v101
  v_fma_f32 v102, -v25, v134, v102
  v_fma_f32 v103, -v25, v135, v103
  v_mul_f32 v96, v96, v27
  s_add_u32 m0, s69, 73728
  s_mul_i32 s68, s70, 57344
  s_add_u32 s68, s68, s71
  buffer_load_dwordx4 v13, s[92:95], s68 offen lds
  s_add_u32 s70, s70, 1
  s_cmp_eq_u32 s70, 28
  s_cselect_b32 s70, 0, s70
  v_mul_f32 v97, v97, v27
  v_mul_f32 v98, v98, v27
  v_mul_f32 v99, v99, v27
  v_mul_f32 v100, v100, v27
  v_mul_f32 v101, v101, v27
  v_mul_f32 v102, v102, v27
  v_mul_f32 v103, v103, v27
  v_exp_f32 v96, v96
  v_fma_f32 v104, -v25, v136, v104
  v_exp_f32 v97, v97
  s_add_u32 m0, s69, 81920
  s_mul_i32 s68, s70, 57344
  s_add_u32 s68, s68, s71
  buffer_load_dwordx4 v13, s[92:95], s68 offen lds
  s_add_u32 s70, s70, 1
  s_cmp_eq_u32 s70, 28
  s_cselect_b32 s70, 0, s70
  v_fma_f32 v105, -v25, v137, v105
  v_exp_f32 v98, v98
  v_fma_f32 v106, -v25, v138, v106
  v_exp_f32 v99, v99
  v_fma_f32 v107, -v25, v139, v107
  v_exp_f32 v100, v100
  v_fma_f32 v108, -v25, v140, v108
  v_exp_f32 v101, v101
  v_fma_f32 v109, -v25, v141, v109
  v_exp_f32 v102, v102
  s_add_u32 m0, s69, 90112
  s_mul_i32 s68, s70, 57344
  s_add_u32 s68, s68, s71
  buffer_load_dwordx4 v13, s[92:95], s68 offen lds
  s_add_u32 s70, s70, 1
  s_cmp_eq_u32 s70, 28
  s_cselect_b32 s70, 0, s70
  v_fma_f32 v110, -v25, v142, v110
  v_exp_f32 v103, v103
  v_fma_f32 v111, -v25, v143, v111
  v_fma_f32 v96, v96, v26, v26
  v_fma_f32 v97, v97, v26, v26
  v_fma_f32 v98, v98, v26, v26
  v_fma_f32 v99, v99, v26, v26
  v_fma_f32 v100, v100, v26, v26
  v_fma_f32 v101, v101, v26, v26
  v_fma_f32 v102, v102, v26, v26
  v_fma_f32 v103, v103, v26, v26
  v_rcp_f32 v96, v96
  v_rcp_f32 v97, v97
  v_rcp_f32 v98, v98
  v_rcp_f32 v99, v99
  v_rcp_f32 v100, v100
  v_rcp_f32 v101, v101
  v_rcp_f32 v102, v102
  v_rcp_f32 v103, v103
  v_mul_f32 v96, v96, v104
  v_mul_f32 v97, v97, v105
  v_mul_f32 v98, v98, v106
  v_mul_f32 v99, v99, v107
  v_mul_f32 v100, v100, v108
  v_mul_f32 v101, v101, v109
  v_mul_f32 v102, v102, v110
  v_mul_f32 v103, v103, v111
  v_cvt_pk_bf16_f32 v104, v96, v97
  v_cvt_pk_bf16_f32 v105, v98, v99
  v_cvt_pk_bf16_f32 v106, v100, v101
  v_cvt_pk_bf16_f32 v107, v102, v103
  s_add_u32 s56, s79, 4096
  buffer_store_dwordx4 v[104:107], v47, s[32:35], s56 offen sc1
  s_waitcnt lgkmcnt(0)
  v_fma_f32 v112, -v25, v144, v112
  v_fma_f32 v113, -v25, v145, v113
  v_fma_f32 v114, -v25, v146, v114
  v_fma_f32 v115, -v25, v147, v115
  v_fma_f32 v116, -v25, v148, v116
  v_fma_f32 v117, -v25, v149, v117
  v_fma_f32 v118, -v25, v150, v118
  v_fma_f32 v119, -v25, v151, v119
  v_mul_f32 v112, v112, v27
  v_mul_f32 v113, v113, v27
  v_mul_f32 v114, v114, v27
  v_mul_f32 v115, v115, v27
  v_mul_f32 v116, v116, v27
  v_mul_f32 v117, v117, v27
  v_mul_f32 v118, v118, v27
  v_mul_f32 v119, v119, v27
  v_exp_f32 v112, v112
  v_fma_f32 v120, -v25, v152, v120
  v_exp_f32 v113, v113
  v_fma_f32 v121, -v25, v153, v121
  v_exp_f32 v114, v114
  v_fma_f32 v122, -v25, v154, v122
  v_exp_f32 v115, v115
  v_fma_f32 v123, -v25, v155, v123
  v_exp_f32 v116, v116
  v_fma_f32 v124, -v25, v156, v124
  v_exp_f32 v117, v117
  v_fma_f32 v125, -v25, v157, v125
  v_exp_f32 v118, v118
  v_fma_f32 v126, -v25, v158, v126
  v_exp_f32 v119, v119
  v_fma_f32 v127, -v25, v159, v127
  v_fma_f32 v112, v112, v26, v26
  v_fma_f32 v113, v113, v26, v26
  v_fma_f32 v114, v114, v26, v26
  v_fma_f32 v115, v115, v26, v26
  v_fma_f32 v116, v116, v26, v26
  v_fma_f32 v117, v117, v26, v26
  v_fma_f32 v118, v118, v26, v26
  v_fma_f32 v119, v119, v26, v26
  v_rcp_f32 v112, v112
  v_rcp_f32 v113, v113
  v_rcp_f32 v114, v114
  v_rcp_f32 v115, v115
  v_rcp_f32 v116, v116
  v_rcp_f32 v117, v117
  v_rcp_f32 v118, v118
  v_rcp_f32 v119, v119
  v_mul_f32 v112, v112, v120
  v_mul_f32 v113, v113, v121
  v_mul_f32 v114, v114, v122
  v_mul_f32 v115, v115, v123
  v_mul_f32 v116, v116, v124
  v_mul_f32 v117, v117, v125
  v_mul_f32 v118, v118, v126
  v_mul_f32 v119, v119, v127
  v_cvt_pk_bf16_f32 v120, v112, v113
  v_cvt_pk_bf16_f32 v121, v114, v115
  v_cvt_pk_bf16_f32 v122, v116, v117
  v_cvt_pk_bf16_f32 v123, v118, v119
  s_add_u32 s56, s79, 5120
  buffer_store_dwordx4 v[120:123], v47, s[32:35], s56 offen sc1
  v_mul_f32 v188, v22, v22
  v_mul_f32 v189, v21, v22
  v_fma_f32 v182, v21, v21, -v188
  v_add_f32 v183, v189, v189
  v_mul_f32 v188, v183, v22
  v_mul_f32 v189, v183, v21
  v_fma_f32 v188, v182, v21, -v188
  v_fma_f32 v185, v182, v22, v189
  v_mov_b32 v184, v188
  v_mul_f32 v188, v183, v183
  v_mul_f32 v189, v182, v183
  v_fma_f32 v186, v182, v182, -v188
  v_add_f32 v187, v189, v189
  v_lshrrev_b32 v190, 4, v0
  s_sub_u32 s63, s52, 1
  v_sub_u32 v190, s63, v190
  v_and_b32 v191, 3, v190
  v_ashrrev_i32 v190, 2, v190
  v_mov_b32 v192, 1.0
  v_mov_b32 v193, 0
  v_cmp_eq_u32 vcc, 1, v191
  s_nop 1
  v_cndmask_b32 v192, v192, v21, vcc
  v_cndmask_b32 v193, v193, v22, vcc
  v_cmp_eq_u32 vcc, 2, v191
  s_nop 1
  v_cndmask_b32 v192, v192, v182, vcc
  v_cndmask_b32 v193, v193, v183, vcc
  v_cmp_eq_u32 vcc, 3, v191
  s_nop 1
  v_cndmask_b32 v192, v192, v184, vcc
  v_cndmask_b32 v193, v193, v185, vcc
  s_cmp_eq_u32 s52, 0
  s_cbranch_scc1 K1_ESK_17
  s_waitcnt vmcnt(6)
  s_mov_b32 s62, 0
K1_ECK_19:
  v_xor_b32 v44, s98, v161
  v_xor_b32 v45, s98, v163
  v_or_b32 v44, v44, v45
  v_xor_b32 v45, s98, v165
  v_or_b32 v44, v44, v45
  v_xor_b32 v45, s98, v167
  v_or_b32 v44, v44, v45
  v_xor_b32 v45, s98, v169
  v_or_b32 v44, v44, v45
  v_xor_b32 v45, s98, v171
  v_or_b32 v44, v44, v45
  v_xor_b32 v45, s98, v173
  v_or_b32 v44, v44, v45
  v_xor_b32 v45, s98, v175
  v_or_b32 v44, v44, v45
  v_cmp_ne_u32 vcc, 0, v44
  s_nop 1
  s_cmp_eq_u64 vcc, 0
  s_cbranch_scc1 K1_EOK_18
  s_add_u32 s62, s62, 1
  s_cmp_ge_u32 s62, 100000
  s_cbranch_scc1 K1_EOK_18
  v_lshrrev_b32 v180, 4, v0
  v_and_b32 v181, 15, v0
  v_add_u32 v181, s78, v181
  v_lshlrev_b32 v181, 4, v181
  s_sub_u32 s63, s52, 1
  s_mov_b32 s61, 11078656
  v_add_u32 v176, 0, v180
  v_min_u32 v176, s63, v176
  v_mul_u32_u24 v176, 7168, v176
  v_add_u32 v176, v176, v181
  buffer_load_dwordx4 v[160:163], v176, s[32:35], s61 offen sc1
  v_add_u32 v177, 4, v180
  v_min_u32 v177, s63, v177
  v_mul_u32_u24 v177, 7168, v177
  v_add_u32 v177, v177, v181
  buffer_load_dwordx4 v[164:167], v177, s[32:35], s61 offen sc1
  v_add_u32 v178, 8, v180
  v_min_u32 v178, s63, v178
  v_mul_u32_u24 v178, 7168, v178
  v_add_u32 v178, v178, v181
  buffer_load_dwordx4 v[168:171], v178, s[32:35], s61 offen sc1
  v_add_u32 v179, 12, v180
  v_min_u32 v179, s63, v179
  v_mul_u32_u24 v179, 7168, v179
  v_add_u32 v179, v179, v181
  buffer_load_dwordx4 v[172:175], v179, s[32:35], s61 offen sc1
  s_waitcnt vmcnt(0)
  s_branch K1_ECK_19
K1_EOK_18:
K1_ESK_17:
  v_mov_b32 v44, 0
  v_mov_b32 v45, 0
  s_cmp_eq_u32 s52, 0
  s_cbranch_scc1 K1_NOCARRY_20
  v_cmp_le_i32 vcc, 0, v190
  v_fma_f32 v160, v186, v44, v160
  v_fma_f32 v162, v186, v45, v162
  v_fma_f32 v160, -v187, v45, v160
  v_fma_f32 v162, v187, v44, v162
  v_cndmask_b32 v44, v44, v160, vcc
  v_cndmask_b32 v45, v45, v162, vcc
  v_cmp_le_i32 vcc, 1, v190
  v_fma_f32 v164, v186, v44, v164
  v_fma_f32 v166, v186, v45, v166
  v_fma_f32 v164, -v187, v45, v164
  v_fma_f32 v166, v187, v44, v166
  v_cndmask_b32 v44, v44, v164, vcc
  v_cndmask_b32 v45, v45, v166, vcc
  v_cmp_le_i32 vcc, 2, v190
  v_fma_f32 v168, v186, v44, v168
  v_fma_f32 v170, v186, v45, v170
  v_fma_f32 v168, -v187, v45, v168
  v_fma_f32 v170, v187, v44, v170
  v_cndmask_b32 v44, v44, v168, vcc
  v_cndmask_b32 v45, v45, v170, vcc
  v_cmp_le_i32 vcc, 3, v190
  v_fma_f32 v172, v186, v44, v172
  v_fma_f32 v174, v186, v45, v174
  v_fma_f32 v172, -v187, v45, v172
  v_fma_f32 v174, v187, v44, v174
  v_cndmask_b32 v44, v44, v172, vcc
  v_cndmask_b32 v45, v45, v174, vcc
  v_mul_f32 v40, v193, v45
  v_mul_f32 v41, v193, v44
  v_fma_f32 v44, v192, v44, -v40
  v_fma_f32 v45, v192, v45, v41
  v_mov_b32 v40, v44
  v_mov_b32 v41, v45
  s_nop 0
  v_permlane16_swap_b32 v44, v40
  v_permlane16_swap_b32 v45, v41
  v_add_f32 v44, v44, v40
  v_add_f32 v45, v45, v41
  v_mov_b32 v40, v44
  v_mov_b32 v41, v45
  s_nop 0
  v_permlane32_swap_b32 v44, v40
  v_permlane32_swap_b32 v45, v41
  v_add_f32 v44, v44, v40
  v_add_f32 v45, v45, v41
K1_NOCARRY_20:
  v_fma_f32 v30, v23, v44, v30
  v_fma_f32 v31, v23, v45, v31
  v_fma_f32 v30, -v24, v45, v30
  v_fma_f32 v31, v24, v44, v31
  v_fma_f32 v48, v15, v30, v48
  v_fma_f32 v56, v15, v31, v56
  v_fma_f32 v48, -v16, v31, v48
  v_fma_f32 v56, v16, v30, v56
  v_fma_f32 v49, v15, v48, v49
  v_fma_f32 v57, v15, v56, v57
  v_fma_f32 v49, -v16, v56, v49
  v_fma_f32 v57, v16, v48, v57
  v_fma_f32 v50, v15, v49, v50
  v_fma_f32 v58, v15, v57, v58
  v_fma_f32 v50, -v16, v57, v50
  v_fma_f32 v58, v16, v49, v58
  v_fma_f32 v51, v15, v50, v51
  v_fma_f32 v59, v15, v58, v59
  v_fma_f32 v51, -v16, v58, v51
  v_fma_f32 v59, v16, v50, v59
  v_fma_f32 v52, v15, v51, v52
  v_fma_f32 v60, v15, v59, v60
  v_fma_f32 v52, -v16, v59, v52
  v_fma_f32 v60, v16, v51, v60
  v_fma_f32 v53, v15, v52, v53
  v_fma_f32 v61, v15, v60, v61
  v_fma_f32 v53, -v16, v60, v53
  v_fma_f32 v61, v16, v52, v61
  v_fma_f32 v54, v15, v53, v54
  v_fma_f32 v62, v15, v61, v62
  v_fma_f32 v54, -v16, v61, v54
  v_fma_f32 v62, v16, v53, v62
  v_fma_f32 v55, v15, v54, v55
  v_fma_f32 v63, v15, v62, v63
  v_fma_f32 v55, -v16, v62, v55
  v_fma_f32 v63, v16, v54, v63
  v_cvt_pk_bf16_f32 v36, v48, v49
  v_cvt_pk_bf16_f32 v40, -v56, -v57
  v_cvt_pk_bf16_f32 v37, v50, v51
  v_cvt_pk_bf16_f32 v41, -v58, -v59
  v_cvt_pk_bf16_f32 v38, v52, v53
  v_cvt_pk_bf16_f32 v42, -v60, -v61
  v_cvt_pk_bf16_f32 v39, v54, v55
  v_cvt_pk_bf16_f32 v43, -v62, -v63
  ds_write_b128 v1, v[36:39]
  ds_write_b128 v1, v[40:43] offset:1024
  s_waitcnt lgkmcnt(0)
  ds_read_b64_tr_b16 v[36:37], v2
  ds_read_b64_tr_b16 v[38:39], v2 offset:256
  ds_read_b64_tr_b16 v[40:41], v2 offset:1024
  ds_read_b64_tr_b16 v[42:43], v2 offset:1280
  s_waitcnt lgkmcnt(0)
  buffer_store_dwordx4 v[36:39], v3, s[32:35], s76 offen sc1
  s_add_u32 s76, s76, 4096
  buffer_store_dwordx4 v[40:43], v3, s[32:35], s76 offen sc1
  s_setprio 0
  s_lshl_b32 s76, s52, 7
  s_add_u32 s76, s76, 11193344
  s_lshl_b32 s79, s53, 2
  s_and_b32 s71, s51, 3
  s_cmp_ge_u32 s53, 7
  s_cselect_b32 s49, 1, 0
  s_cselect_b32 s50, 7, 0
  s_sub_u32 s50, s53, s50
  s_lshl_b32 s51, s52, 1
  s_add_u32 s49, s49, s51
  s_mov_b32 s72, s32
  s_mov_b32 s73, s33
  s_mov_b32 s74, s34
  s_mov_b32 s75, s35
  s_load_dwordx2 s[4:5], s[0:1], 0
  s_load_dwordx2 s[6:7], s[0:1], 40
  s_load_dwordx2 s[8:9], s[0:1], 48
  s_load_dwordx2 s[10:11], s[0:1], 64
  s_load_dwordx2 s[12:13], s[0:1], 96
  s_load_dwordx2 s[14:15], s[0:1], 104
  s_load_dwordx2 s[16:17], s[0:1], 120
  s_waitcnt lgkmcnt(0)
  s_mov_b32 s20, s4
  s_and_b32 s21, s5, 0xffff
  s_mov_b32 s22, 1835008
  s_mov_b32 s23, 0x20000
  s_mov_b32 s24, s6
  s_and_b32 s25, s7, 0xffff
  s_mov_b32 s26, 401408
  s_mov_b32 s27, 0x20000
  s_mov_b32 s28, s8
  s_and_b32 s29, s9, 0xffff
  s_mov_b32 s30, 401408
  s_mov_b32 s31, 0x20000
  s_mov_b32 s32, s10
  s_and_b32 s33, s11, 0xffff
  s_mov_b32 s34, 896
  s_mov_b32 s35, 0x20000
  s_mov_b32 s36, s12
  s_and_b32 s37, s13, 0xffff
  s_mov_b32 s38, 1605632
  s_mov_b32 s39, 0x20000
  s_mov_b32 s40, s14
  s_and_b32 s41, s15, 0xffff
  s_mov_b32 s42, 3670016
  s_mov_b32 s43, 0x20000
  s_mov_b32 s44, s16
  s_and_b32 s45, s17, 0xffff
  s_mov_b32 s46, 11195392
  s_mov_b32 s47, 0x20000
  s_waitcnt vmcnt(2) lgkmcnt(0)
  s_barrier
  s_cmp_lg_u32 s48, 0
  s_cbranch_scc1 F_NOADD_21
  v_mov_b32 v2, s79
  v_mov_b32 v3, s98
  s_mov_b64 exec, 1
  buffer_store_dword v3, v2, s[72:75], s76 offen sc1
  s_mov_b64 exec, -1
F_NOADD_21:
  s_cmp_ge_u32 s48, 4
  s_cbranch_scc1 K2_LOADER
  s_and_b32 s52, s48, 1
  s_lshr_b32 s53, s48, 1
  v_and_b32 v1, 31, v0
  v_lshrrev_b32 v2, 5, v0
  v_and_b32 v3, 15, v0
  v_lshrrev_b32 v4, 4, v0
  s_lshl_b32 s54, s49, 6
  s_lshl_b32 s55, s52, 5
  s_add_u32 s54, s54, s55
  v_add_u32 v5, s54, v1
  s_lshl_b32 s55, s50, 6
  s_lshl_b32 s56, s53, 5
  s_add_u32 s55, s55, s56
  v_lshlrev_b32 v6, 2, v2
  v_add_u32 v6, s55, v6
  s_movk_i32 s57, 896
  v_mul_lo_u32 v7, s57, v5
  v_lshlrev_b32 v8, 1, v6
  v_add_u32 v7, v7, v8
  v_lshlrev_b32 v9, 4, v5
  v_add_u32 v9, 11010048, v9
  v_lshlrev_b32 v10, 1, v7
  buffer_load_dwordx2 v[16:17], v7, s[20:23], 0 offen offset:0
  buffer_load_dwordx2 v[18:19], v7, s[20:23], 0 offen offset:16
  buffer_load_dwordx2 v[20:21], v7, s[20:23], 0 offen offset:32
  buffer_load_dwordx2 v[22:23], v7, s[20:23], 0 offen offset:48
  buffer_load_dwordx2 v[24:25], v8, s[32:35], 0 offen offset:0
  buffer_load_dwordx2 v[26:27], v8, s[32:35], 0 offen offset:16
  buffer_load_dwordx2 v[28:29], v8, s[32:35], 0 offen offset:32
  buffer_load_dwordx2 v[30:31], v8, s[32:35], 0 offen offset:48
  buffer_load_dwordx4 v[192:195], v9, s[44:47], 0 offen sc1
  s_lshl_b32 s57, s52, 12
  v_lshlrev_b32 v11, 4, v0
  v_add_u32 v11, s57, v11
  v_lshrrev_b32 v13, 2, v3
  v_lshl_add_u32 v13, v2, 2, v13
  v_lshlrev_b32 v12, 7, v13
  v_and_b32 v13, 1, v4
  s_lshl_b32 s57, s53, 1
  v_add_u32 v13, s57, v13
  v_lshrrev_b32 v14, 3, v3
  v_lshlrev_b32 v14, 1, v14
  v_xor_b32 v13, v13, v14
  v_lshl_add_u32 v12, v13, 5, v12
  v_and_b32 v13, 3, v3
  v_lshl_add_u32 v12, v13, 3, v12
  s_lshl_b32 s57, s53, 5
  v_add_u32 v13, s57, v1
  v_lshlrev_b32 v13, 7, v13
  v_lshrrev_b32 v14, 1, v1
  v_and_b32 v14, 7, v14
  v_xor_b32 v14, v14, v2
  v_lshl_add_u32 v13, v14, 4, v13
  s_barrier
  v_add_u32 v14, 122880, v11
  v_add_u32 v15, 0, v12
  ds_read_b128 v[96:99], v14 offset:0
  ds_read_b64_tr_b16 v[100:101], v15 offset:0
  ds_read_b64_tr_b16 v[102:103], v15 offset:1024
  s_waitcnt vmcnt(0)
  v_rcp_f32 v50, v194
  v_lshlrev_b32 v34, 16, v16
  v_and_b32 v35, 0xffff0000, v16
  v_sub_f32 v51, v34, v192
  v_sub_f32 v52, v35, v192
  ds_read_b128 v[104:107], v14 offset:1024
  ds_read_b64_tr_b16 v[108:109], v15 offset:2048
  ds_read_b64_tr_b16 v[110:111], v15 offset:3072
  v_cvt_pk_bf16_f32 v53, v51, v52
  v_lshlrev_b32 v51, 16, v53
  v_and_b32 v52, 0xffff0000, v53
  v_mul_f32 v51, v51, v50
  v_mul_f32 v52, v52, v50
  v_cvt_pk_bf16_f32 v53, v51, v52
  ds_read_b128 v[112:115], v14 offset:2048
  ds_read_b64_tr_b16 v[116:117], v15 offset:4096
  ds_read_b64_tr_b16 v[118:119], v15 offset:5120
  v_lshlrev_b32 v51, 16, v53
  v_and_b32 v52, 0xffff0000, v53
  v_lshlrev_b32 v54, 16, v24
  v_and_b32 v55, 0xffff0000, v24
  v_mul_f32 v51, v51, v54
  v_mul_f32 v52, v52, v55
  ds_read_b128 v[120:123], v14 offset:3072
  ds_read_b64_tr_b16 v[124:125], v15 offset:6144
  ds_read_b64_tr_b16 v[126:127], v15 offset:7168
  v_cvt_pk_bf16_f32 v53, v51, v52
  v_lshlrev_b32 v160, 16, v53
  v_and_b32 v161, 0xffff0000, v53
  v_lshlrev_b32 v36, 16, v17
  v_and_b32 v37, 0xffff0000, v17
  v_sub_f32 v51, v36, v192
  s_barrier
  v_add_u32 v14, 131072, v11
  v_add_u32 v15, 8192, v12
  s_waitcnt lgkmcnt(9)
  v_mfma_f32_32x32x16_bf16 v[64:79], v[100:103], v[96:99], 0
  ds_read_b128 v[128:131], v14 offset:0
  ds_read_b64_tr_b16 v[132:133], v15 offset:0
  ds_read_b64_tr_b16 v[134:135], v15 offset:1024
  v_sub_f32 v52, v37, v192
  v_cvt_pk_bf16_f32 v53, v51, v52
  v_lshlrev_b32 v51, 16, v53
  v_and_b32 v52, 0xffff0000, v53
  v_mul_f32 v51, v51, v50
  v_mul_f32 v52, v52, v50
  s_waitcnt lgkmcnt(9)
  v_mfma_f32_32x32x16_bf16 v[64:79], v[108:111], v[104:107], v[64:79]
  ds_read_b128 v[136:139], v14 offset:1024
  ds_read_b64_tr_b16 v[140:141], v15 offset:2048
  ds_read_b64_tr_b16 v[142:143], v15 offset:3072
  v_cvt_pk_bf16_f32 v53, v51, v52
  v_lshlrev_b32 v51, 16, v53
  v_and_b32 v52, 0xffff0000, v53
  v_lshlrev_b32 v54, 16, v25
  v_and_b32 v55, 0xffff0000, v25
  v_mul_f32 v51, v51, v54
  s_waitcnt lgkmcnt(9)
  v_mfma_f32_32x32x16_bf16 v[64:79], v[116:119], v[112:115], v[64:79]
  ds_read_b128 v[144:147], v14 offset:2048
  ds_read_b64_tr_b16 v[148:149], v15 offset:4096
  ds_read_b64_tr_b16 v[150:151], v15 offset:5120
  v_mul_f32 v52, v52, v55
  v_cvt_pk_bf16_f32 v53, v51, v52
  v_lshlrev_b32 v162, 16, v53
  v_and_b32 v163, 0xffff0000, v53
  v_lshlrev_b32 v38, 16, v18
  v_and_b32 v39, 0xffff0000, v18
  s_waitcnt lgkmcnt(9)
  v_mfma_f32_32x32x16_bf16 v[64:79], v[124:127], v[120:123], v[64:79]
  ds_read_b128 v[152:155], v14 offset:3072
  ds_read_b64_tr_b16 v[156:157], v15 offset:6144
  ds_read_b64_tr_b16 v[158:159], v15 offset:7168
  v_sub_f32 v51, v38, v192
  v_sub_f32 v52, v39, v192
  v_cvt_pk_bf16_f32 v53, v51, v52
  v_lshlrev_b32 v51, 16, v53
  v_and_b32 v52, 0xffff0000, v53
  v_mul_f32 v51, v51, v50
  s_barrier
  v_add_u32 v14, 139264, v11
  v_add_u32 v15, 16384, v12
  s_waitcnt lgkmcnt(9)
  v_mfma_f32_32x32x16_bf16 v[64:79], v[132:135], v[128:131], v[64:79]
  ds_read_b128 v[96:99], v14 offset:0
  ds_read_b64_tr_b16 v[100:101], v15 offset:0
  ds_read_b64_tr_b16 v[102:103], v15 offset:1024
  v_mul_f32 v52, v52, v50
  v_cvt_pk_bf16_f32 v53, v51, v52
  v_lshlrev_b32 v51, 16, v53
  v_and_b32 v52, 0xffff0000, v53
  v_lshlrev_b32 v54, 16, v26
  v_and_b32 v55, 0xffff0000, v26
  s_waitcnt lgkmcnt(9)
  v_mfma_f32_32x32x16_bf16 v[64:79], v[140:143], v[136:139], v[64:79]
  ds_read_b128 v[104:107], v14 offset:1024
  ds_read_b64_tr_b16 v[108:109], v15 offset:2048
  ds_read_b64_tr_b16 v[110:111], v15 offset:3072
  v_mul_f32 v51, v51, v54
  v_mul_f32 v52, v52, v55
  v_cvt_pk_bf16_f32 v53, v51, v52
  v_lshlrev_b32 v164, 16, v53
  v_and_b32 v165, 0xffff0000, v53
  v_lshlrev_b32 v40, 16, v19
  s_waitcnt lgkmcnt(9)
  v_mfma_f32_32x32x16_bf16 v[64:79], v[148:151], v[144:147], v[64:79]
  ds_read_b128 v[112:115], v14 offset:2048
  ds_read_b64_tr_b16 v[116:117], v15 offset:4096
  ds_read_b64_tr_b16 v[118:119], v15 offset:5120
  v_and_b32 v41, 0xffff0000, v19
  v_sub_f32 v51, v40, v192
  v_sub_f32 v52, v41, v192
  v_cvt_pk_bf16_f32 v53, v51, v52
  v_lshlrev_b32 v51, 16, v53
  v_and_b32 v52, 0xffff0000, v53
  s_waitcnt lgkmcnt(9)
  v_mfma_f32_32x32x16_bf16 v[64:79], v[156:159], v[152:155], v[64:79]
  ds_read_b128 v[120:123], v14 offset:3072
  ds_read_b64_tr_b16 v[124:125], v15 offset:6144
  ds_read_b64_tr_b16 v[126:127], v15 offset:7168
  v_mul_f32 v51, v51, v50
  v_mul_f32 v52, v52, v50
  v_cvt_pk_bf16_f32 v53, v51, v52
  v_lshlrev_b32 v51, 16, v53
  v_and_b32 v52, 0xffff0000, v53
  v_lshlrev_b32 v54, 16, v27
  s_waitcnt vmcnt(0)
  s_barrier
  s_cmp_lg_u32 s48, 0
  s_cbranch_scc1 F_NOH_22
  v_mov_b32 v56, s79
  v_mov_b32 v57, s98
  s_mov_b64 exec, 1
  buffer_store_dword v57, v56, s[72:75], s76 offen offset:64 sc1
  s_mov_b64 exec, -1
F_NOH_22:
  v_add_u32 v14, 147456, v11
  v_add_u32 v15, 24576, v12
  s_waitcnt lgkmcnt(9)
  v_mfma_f32_32x32x16_bf16 v[64:79], v[100:103], v[96:99], v[64:79]
  ds_read_b128 v[128:131], v14 offset:0
  ds_read_b64_tr_b16 v[132:133], v15 offset:0
  ds_read_b64_tr_b16 v[134:135], v15 offset:1024
  v_and_b32 v55, 0xffff0000, v27
  v_mul_f32 v51, v51, v54
  v_mul_f32 v52, v52, v55
  v_cvt_pk_bf16_f32 v53, v51, v52
  v_lshlrev_b32 v166, 16, v53
  v_and_b32 v167, 0xffff0000, v53
  s_waitcnt lgkmcnt(9)
  v_mfma_f32_32x32x16_bf16 v[64:79], v[108:111], v[104:107], v[64:79]
  ds_read_b128 v[136:139], v14 offset:1024
  ds_read_b64_tr_b16 v[140:141], v15 offset:2048
  ds_read_b64_tr_b16 v[142:143], v15 offset:3072
  v_lshlrev_b32 v42, 16, v20
  v_and_b32 v43, 0xffff0000, v20
  v_sub_f32 v51, v42, v192
  v_sub_f32 v52, v43, v192
  v_cvt_pk_bf16_f32 v53, v51, v52
  v_lshlrev_b32 v51, 16, v53
  s_waitcnt lgkmcnt(9)
  v_mfma_f32_32x32x16_bf16 v[64:79], v[116:119], v[112:115], v[64:79]
  ds_read_b128 v[144:147], v14 offset:2048
  ds_read_b64_tr_b16 v[148:149], v15 offset:4096
  ds_read_b64_tr_b16 v[150:151], v15 offset:5120
  v_and_b32 v52, 0xffff0000, v53
  v_mul_f32 v51, v51, v50
  v_mul_f32 v52, v52, v50
  v_cvt_pk_bf16_f32 v53, v51, v52
  v_lshlrev_b32 v51, 16, v53
  v_and_b32 v52, 0xffff0000, v53
  s_waitcnt lgkmcnt(9)
  v_mfma_f32_32x32x16_bf16 v[64:79], v[124:127], v[120:123], v[64:79]
  ds_read_b128 v[152:155], v14 offset:3072
  ds_read_b64_tr_b16 v[156:157], v15 offset:6144
  ds_read_b64_tr_b16 v[158:159], v15 offset:7168
  v_lshlrev_b32 v54, 16, v28
  v_and_b32 v55, 0xffff0000, v28
  v_mul_f32 v51, v51, v54
  v_mul_f32 v52, v52, v55
  v_cvt_pk_bf16_f32 v53, v51, v52
  v_lshlrev_b32 v168, 16, v53
  s_barrier
  v_add_u32 v14, 155648, v11
  v_add_u32 v15, 32768, v12
  s_waitcnt lgkmcnt(9)
  v_mfma_f32_32x32x16_bf16 v[64:79], v[132:135], v[128:131], v[64:79]
  ds_read_b128 v[96:99], v14 offset:0
  ds_read_b64_tr_b16 v[100:101], v15 offset:0
  ds_read_b64_tr_b16 v[102:103], v15 offset:1024
  v_and_b32 v169, 0xffff0000, v53
  v_lshlrev_b32 v44, 16, v21
  v_and_b32 v45, 0xffff0000, v21
  v_sub_f32 v51, v44, v192
  v_sub_f32 v52, v45, v192
  v_cvt_pk_bf16_f32 v53, v51, v52
  s_waitcnt lgkmcnt(9)
  v_mfma_f32_32x32x16_bf16 v[64:79], v[140:143], v[136:139], v[64:79]
  ds_read_b128 v[104:107], v14 offset:1024
  ds_read_b64_tr_b16 v[108:109], v15 offset:2048
  ds_read_b64_tr_b16 v[110:111], v15 offset:3072
  v_lshlrev_b32 v51, 16, v53
  v_and_b32 v52, 0xffff0000, v53
  v_mul_f32 v51, v51, v50
  v_mul_f32 v52, v52, v50
  v_cvt_pk_bf16_f32 v53, v51, v52
  v_lshlrev_b32 v51, 16, v53
  s_waitcnt lgkmcnt(9)
  v_mfma_f32_32x32x16_bf16 v[64:79], v[148:151], v[144:147], v[64:79]
  ds_read_b128 v[112:115], v14 offset:2048
  ds_read_b64_tr_b16 v[116:117], v15 offset:4096
  ds_read_b64_tr_b16 v[118:119], v15 offset:5120
  v_and_b32 v52, 0xffff0000, v53
  v_lshlrev_b32 v54, 16, v29
  v_and_b32 v55, 0xffff0000, v29
  v_mul_f32 v51, v51, v54
  v_mul_f32 v52, v52, v55
  v_cvt_pk_bf16_f32 v53, v51, v52
  s_waitcnt lgkmcnt(9)
  v_mfma_f32_32x32x16_bf16 v[64:79], v[156:159], v[152:155], v[64:79]
  ds_read_b128 v[120:123], v14 offset:3072
  ds_read_b64_tr_b16 v[124:125], v15 offset:6144
  ds_read_b64_tr_b16 v[126:127], v15 offset:7168
  v_lshlrev_b32 v170, 16, v53
  v_and_b32 v171, 0xffff0000, v53
  v_lshlrev_b32 v46, 16, v22
  v_and_b32 v47, 0xffff0000, v22
  v_sub_f32 v51, v46, v192
  v_sub_f32 v52, v47, v192
  s_barrier
  v_add_u32 v14, 122880, v11
  v_add_u32 v15, 40960, v12
  s_waitcnt lgkmcnt(9)
  v_mfma_f32_32x32x16_bf16 v[64:79], v[100:103], v[96:99], v[64:79]
  ds_read_b128 v[128:131], v14 offset:0
  ds_read_b64_tr_b16 v[132:133], v15 offset:0
  ds_read_b64_tr_b16 v[134:135], v15 offset:1024
  v_cvt_pk_bf16_f32 v53, v51, v52
  v_lshlrev_b32 v51, 16, v53
  v_and_b32 v52, 0xffff0000, v53
  v_mul_f32 v51, v51, v50
  v_mul_f32 v52, v52, v50
  v_cvt_pk_bf16_f32 v53, v51, v52
  s_waitcnt lgkmcnt(9)
  v_mfma_f32_32x32x16_bf16 v[64:79], v[108:111], v[104:107], v[64:79]
  ds_read_b128 v[136:139], v14 offset:1024
  ds_read_b64_tr_b16 v[140:141], v15 offset:2048
  ds_read_b64_tr_b16 v[142:143], v15 offset:3072
  v_lshlrev_b32 v51, 16, v53
  v_and_b32 v52, 0xffff0000, v53
  v_lshlrev_b32 v54, 16, v30
  v_and_b32 v55, 0xffff0000, v30
  v_mul_f32 v51, v51, v54
  v_mul_f32 v52, v52, v55
  s_waitcnt lgkmcnt(9)
  v_mfma_f32_32x32x16_bf16 v[64:79], v[116:119], v[112:115], v[64:79]
  ds_read_b128 v[144:147], v14 offset:2048
  ds_read_b64_tr_b16 v[148:149], v15 offset:4096
  ds_read_b64_tr_b16 v[150:151], v15 offset:5120
  v_cvt_pk_bf16_f32 v53, v51, v52
  v_lshlrev_b32 v172, 16, v53
  v_and_b32 v173, 0xffff0000, v53
  v_lshlrev_b32 v48, 16, v23
  v_and_b32 v49, 0xffff0000, v23
  v_sub_f32 v51, v48, v192
  s_waitcnt lgkmcnt(9)
  v_mfma_f32_32x32x16_bf16 v[64:79], v[124:127], v[120:123], v[64:79]
  ds_read_b128 v[152:155], v14 offset:3072
  ds_read_b64_tr_b16 v[156:157], v15 offset:6144
  ds_read_b64_tr_b16 v[158:159], v15 offset:7168
  v_sub_f32 v52, v49, v192
  v_cvt_pk_bf16_f32 v53, v51, v52
  v_lshlrev_b32 v51, 16, v53
  v_and_b32 v52, 0xffff0000, v53
  v_mul_f32 v51, v51, v50
  v_mul_f32 v52, v52, v50
  s_barrier
  v_add_u32 v14, 131072, v11
  v_add_u32 v15, 49152, v12
  s_waitcnt lgkmcnt(9)
  v_mfma_f32_32x32x16_bf16 v[64:79], v[132:135], v[128:131], v[64:79]
  ds_read_b128 v[96:99], v14 offset:0
  ds_read_b64_tr_b16 v[100:101], v15 offset:0
  ds_read_b64_tr_b16 v[102:103], v15 offset:1024
  v_cvt_pk_bf16_f32 v53, v51, v52
  v_lshlrev_b32 v51, 16, v53
  v_and_b32 v52, 0xffff0000, v53
  v_lshlrev_b32 v54, 16, v31
  v_and_b32 v55, 0xffff0000, v31
  v_mul_f32 v51, v51, v54
  s_waitcnt lgkmcnt(9)
  v_mfma_f32_32x32x16_bf16 v[64:79], v[140:143], v[136:139], v[64:79]
  ds_read_b128 v[104:107], v14 offset:1024
  ds_read_b64_tr_b16 v[108:109], v15 offset:2048
  ds_read_b64_tr_b16 v[110:111], v15 offset:3072
  v_mul_f32 v52, v52, v55
  v_cvt_pk_bf16_f32 v53, v51, v52
  v_lshlrev_b32 v174, 16, v53
  v_and_b32 v175, 0xffff0000, v53
  s_waitcnt lgkmcnt(9)
  v_mfma_f32_32x32x16_bf16 v[64:79], v[148:151], v[144:147], v[64:79]
  ds_read_b128 v[112:115], v14 offset:2048
  ds_read_b64_tr_b16 v[116:117], v15 offset:4096
  ds_read_b64_tr_b16 v[118:119], v15 offset:5120
  s_waitcnt lgkmcnt(9)
  v_mfma_f32_32x32x16_bf16 v[64:79], v[156:159], v[152:155], v[64:79]
  ds_read_b128 v[120:123], v14 offset:3072
  ds_read_b64_tr_b16 v[124:125], v15 offset:6144
  ds_read_b64_tr_b16 v[126:127], v15 offset:7168
  s_barrier
  v_add_u32 v14, 139264, v11
  v_add_u32 v15, 57344, v12
  s_waitcnt lgkmcnt(9)
  v_mfma_f32_32x32x16_bf16 v[64:79], v[100:103], v[96:99], v[64:79]
  ds_read_b128 v[128:131], v14 offset:0
  ds_read_b64_tr_b16 v[132:133], v15 offset:0
  ds_read_b64_tr_b16 v[134:135], v15 offset:1024
  s_waitcnt lgkmcnt(9)
  v_mfma_f32_32x32x16_bf16 v[64:79], v[108:111], v[104:107], v[64:79]
  ds_read_b128 v[136:139], v14 offset:1024
  ds_read_b64_tr_b16 v[140:141], v15 offset:2048
  ds_read_b64_tr_b16 v[142:143], v15 offset:3072
  s_waitcnt lgkmcnt(9)
  v_mfma_f32_32x32x16_bf16 v[64:79], v[116:119], v[112:115], v[64:79]
  ds_read_b128 v[144:147], v14 offset:2048
  ds_read_b64_tr_b16 v[148:149], v15 offset:4096
  ds_read_b64_tr_b16 v[150:151], v15 offset:5120
  s_waitcnt lgkmcnt(9)
  v_mfma_f32_32x32x16_bf16 v[64:79], v[124:127], v[120:123], v[64:79]
  ds_read_b128 v[152:155], v14 offset:3072
  ds_read_b64_tr_b16 v[156:157], v15 offset:6144
  ds_read_b64_tr_b16 v[158:159], v15 offset:7168
  s_barrier
  v_add_u32 v14, 147456, v11
  v_add_u32 v15, 65536, v12
  s_waitcnt lgkmcnt(9)
  v_mfma_f32_32x32x16_bf16 v[64:79], v[132:135], v[128:131], v[64:79]
  ds_read_b128 v[96:99], v14 offset:0
  ds_read_b64_tr_b16 v[100:101], v15 offset:0
  ds_read_b64_tr_b16 v[102:103], v15 offset:1024
  s_waitcnt lgkmcnt(9)
  v_mfma_f32_32x32x16_bf16 v[64:79], v[140:143], v[136:139], v[64:79]
  ds_read_b128 v[104:107], v14 offset:1024
  ds_read_b64_tr_b16 v[108:109], v15 offset:2048
  ds_read_b64_tr_b16 v[110:111], v15 offset:3072
  s_waitcnt lgkmcnt(9)
  v_mfma_f32_32x32x16_bf16 v[64:79], v[148:151], v[144:147], v[64:79]
  ds_read_b128 v[112:115], v14 offset:2048
  ds_read_b64_tr_b16 v[116:117], v15 offset:4096
  ds_read_b64_tr_b16 v[118:119], v15 offset:5120
  s_waitcnt lgkmcnt(9)
  v_mfma_f32_32x32x16_bf16 v[64:79], v[156:159], v[152:155], v[64:79]
  ds_read_b128 v[120:123], v14 offset:3072
  ds_read_b64_tr_b16 v[124:125], v15 offset:6144
  ds_read_b64_tr_b16 v[126:127], v15 offset:7168
  s_barrier
  v_add_u32 v14, 155648, v11
  v_add_u32 v15, 73728, v12
  s_waitcnt lgkmcnt(9)
  v_mfma_f32_32x32x16_bf16 v[64:79], v[100:103], v[96:99], v[64:79]
  ds_read_b128 v[128:131], v14 offset:0
  ds_read_b64_tr_b16 v[132:133], v15 offset:0
  ds_read_b64_tr_b16 v[134:135], v15 offset:1024
  s_waitcnt lgkmcnt(9)
  v_mfma_f32_32x32x16_bf16 v[64:79], v[108:111], v[104:107], v[64:79]
  ds_read_b128 v[136:139], v14 offset:1024
  ds_read_b64_tr_b16 v[140:141], v15 offset:2048
  ds_read_b64_tr_b16 v[142:143], v15 offset:3072
  s_waitcnt lgkmcnt(9)
  v_mfma_f32_32x32x16_bf16 v[64:79], v[116:119], v[112:115], v[64:79]
  ds_read_b128 v[144:147], v14 offset:2048
  ds_read_b64_tr_b16 v[148:149], v15 offset:4096
  ds_read_b64_tr_b16 v[150:151], v15 offset:5120
  s_waitcnt lgkmcnt(9)
  v_mfma_f32_32x32x16_bf16 v[64:79], v[124:127], v[120:123], v[64:79]
  ds_read_b128 v[152:155], v14 offset:3072
  ds_read_b64_tr_b16 v[156:157], v15 offset:6144
  ds_read_b64_tr_b16 v[158:159], v15 offset:7168
  s_barrier
  v_add_u32 v14, 122880, v11
  v_add_u32 v15, 81920, v12
  s_waitcnt lgkmcnt(9)
  v_mfma_f32_32x32x16_bf16 v[64:79], v[132:135], v[128:131], v[64:79]
  ds_read_b128 v[96:99], v14 offset:0
  ds_read_b64_tr_b16 v[100:101], v15 offset:0
  ds_read_b64_tr_b16 v[102:103], v15 offset:1024
  s_waitcnt lgkmcnt(9)
  v_mfma_f32_32x32x16_bf16 v[64:79], v[140:143], v[136:139], v[64:79]
  ds_read_b128 v[104:107], v14 offset:1024
  ds_read_b64_tr_b16 v[108:109], v15 offset:2048
  ds_read_b64_tr_b16 v[110:111], v15 offset:3072
  s_waitcnt lgkmcnt(9)
  v_mfma_f32_32x32x16_bf16 v[64:79], v[148:151], v[144:147], v[64:79]
  ds_read_b128 v[112:115], v14 offset:2048
  ds_read_b64_tr_b16 v[116:117], v15 offset:4096
  ds_read_b64_tr_b16 v[118:119], v15 offset:5120
  s_waitcnt lgkmcnt(9)
  v_mfma_f32_32x32x16_bf16 v[64:79], v[156:159], v[152:155], v[64:79]
  ds_read_b128 v[120:123], v14 offset:3072
  ds_read_b64_tr_b16 v[124:125], v15 offset:6144
  ds_read_b64_tr_b16 v[126:127], v15 offset:7168
  s_barrier
  v_add_u32 v14, 131072, v11
  v_add_u32 v15, 90112, v12
  s_waitcnt lgkmcnt(9)
  v_mfma_f32_32x32x16_bf16 v[64:79], v[100:103], v[96:99], v[64:79]
  ds_read_b128 v[128:131], v14 offset:0
  ds_read_b64_tr_b16 v[132:133], v15 offset:0
  ds_read_b64_tr_b16 v[134:135], v15 offset:1024
  s_waitcnt lgkmcnt(9)
  v_mfma_f32_32x32x16_bf16 v[64:79], v[108:111], v[104:107], v[64:79]
  ds_read_b128 v[136:139], v14 offset:1024
  ds_read_b64_tr_b16 v[140:141], v15 offset:2048
  ds_read_b64_tr_b16 v[142:143], v15 offset:3072
  s_waitcnt lgkmcnt(9)
  v_mfma_f32_32x32x16_bf16 v[64:79], v[116:119], v[112:115], v[64:79]
  ds_read_b128 v[144:147], v14 offset:2048
  ds_read_b64_tr_b16 v[148:149], v15 offset:4096
  ds_read_b64_tr_b16 v[150:151], v15 offset:5120
  s_waitcnt lgkmcnt(9)
  v_mfma_f32_32x32x16_bf16 v[64:79], v[124:127], v[120:123], v[64:79]
  ds_read_b128 v[152:155], v14 offset:3072
  ds_read_b64_tr_b16 v[156:157], v15 offset:6144
  ds_read_b64_tr_b16 v[158:159], v15 offset:7168
  s_barrier
  v_add_u32 v14, 139264, v11
  v_add_u32 v15, 98304, v12
  s_waitcnt lgkmcnt(9)
  v_mfma_f32_32x32x16_bf16 v[64:79], v[132:135], v[128:131], v[64:79]
  ds_read_b128 v[96:99], v14 offset:0
  ds_read_b64_tr_b16 v[100:101], v15 offset:0
  ds_read_b64_tr_b16 v[102:103], v15 offset:1024
  s_waitcnt lgkmcnt(9)
  v_mfma_f32_32x32x16_bf16 v[64:79], v[140:143], v[136:139], v[64:79]
  ds_read_b128 v[104:107], v14 offset:1024
  ds_read_b64_tr_b16 v[108:109], v15 offset:2048
  ds_read_b64_tr_b16 v[110:111], v15 offset:3072
  s_waitcnt lgkmcnt(9)
  v_mfma_f32_32x32x16_bf16 v[64:79], v[148:151], v[144:147], v[64:79]
  ds_read_b128 v[112:115], v14 offset:2048
  ds_read_b64_tr_b16 v[116:117], v15 offset:4096
  ds_read_b64_tr_b16 v[118:119], v15 offset:5120
  s_waitcnt lgkmcnt(9)
  v_mfma_f32_32x32x16_bf16 v[64:79], v[156:159], v[152:155], v[64:79]
  ds_read_b128 v[120:123], v14 offset:3072
  ds_read_b64_tr_b16 v[124:125], v15 offset:6144
  ds_read_b64_tr_b16 v[126:127], v15 offset:7168
  s_barrier
  v_add_u32 v14, 147456, v11
  v_add_u32 v15, 106496, v12
  s_waitcnt lgkmcnt(9)
  v_mfma_f32_32x32x16_bf16 v[64:79], v[100:103], v[96:99], v[64:79]
  ds_read_b128 v[128:131], v14 offset:0
  ds_read_b64_tr_b16 v[132:133], v15 offset:0
  ds_read_b64_tr_b16 v[134:135], v15 offset:1024
  s_waitcnt lgkmcnt(9)
  v_mfma_f32_32x32x16_bf16 v[64:79], v[108:111], v[104:107], v[64:79]
  ds_read_b128 v[136:139], v14 offset:1024
  ds_read_b64_tr_b16 v[140:141], v15 offset:2048
  ds_read_b64_tr_b16 v[142:143], v15 offset:3072
  s_waitcnt lgkmcnt(9)
  v_mfma_f32_32x32x16_bf16 v[64:79], v[116:119], v[112:115], v[64:79]
  ds_read_b128 v[144:147], v14 offset:2048
  ds_read_b64_tr_b16 v[148:149], v15 offset:4096
  ds_read_b64_tr_b16 v[150:151], v15 offset:5120
  s_waitcnt lgkmcnt(9)
  v_mfma_f32_32x32x16_bf16 v[64:79], v[124:127], v[120:123], v[64:79]
  ds_read_b128 v[152:155], v14 offset:3072
  ds_read_b64_tr_b16 v[156:157], v15 offset:6144
  ds_read_b64_tr_b16 v[158:159], v15 offset:7168
  s_barrier
  v_add_u32 v14, 155648, v11
  v_add_u32 v15, 114688, v12
  s_waitcnt lgkmcnt(9)
  v_mfma_f32_32x32x16_bf16 v[64:79], v[132:135], v[128:131], v[64:79]
  ds_read_b128 v[96:99], v14 offset:0
  ds_read_b64_tr_b16 v[100:101], v15 offset:0
  ds_read_b64_tr_b16 v[102:103], v15 offset:1024
  s_waitcnt lgkmcnt(9)
  v_mfma_f32_32x32x16_bf16 v[64:79], v[140:143], v[136:139], v[64:79]
  ds_read_b128 v[104:107], v14 offset:1024
  ds_read_b64_tr_b16 v[108:109], v15 offset:2048
  ds_read_b64_tr_b16 v[110:111], v15 offset:3072
  s_waitcnt lgkmcnt(9)
  v_mfma_f32_32x32x16_bf16 v[64:79], v[148:151], v[144:147], v[64:79]
  ds_read_b128 v[112:115], v14 offset:2048
  ds_read_b64_tr_b16 v[116:117], v15 offset:4096
  ds_read_b64_tr_b16 v[118:119], v15 offset:5120
  s_waitcnt lgkmcnt(9)
  v_mfma_f32_32x32x16_bf16 v[64:79], v[156:159], v[152:155], v[64:79]
  ds_read_b128 v[120:123], v14 offset:3072
  ds_read_b64_tr_b16 v[124:125], v15 offset:6144
  ds_read_b64_tr_b16 v[126:127], v15 offset:7168
  s_barrier
  v_add_u32 v14, 122880, v11
  v_add_u32 v15, 0, v12
  s_waitcnt lgkmcnt(9)
  v_mfma_f32_32x32x16_bf16 v[64:79], v[100:103], v[96:99], v[64:79]
  ds_read_b128 v[128:131], v14 offset:0
  ds_read_b64_tr_b16 v[132:133], v15 offset:0
  ds_read_b64_tr_b16 v[134:135], v15 offset:1024
  s_waitcnt lgkmcnt(9)
  v_mfma_f32_32x32x16_bf16 v[64:79], v[108:111], v[104:107], v[64:79]
  ds_read_b128 v[136:139], v14 offset:1024
  ds_read_b64_tr_b16 v[140:141], v15 offset:2048
  ds_read_b64_tr_b16 v[142:143], v15 offset:3072
  s_waitcnt lgkmcnt(9)
  v_mfma_f32_32x32x16_bf16 v[64:79], v[116:119], v[112:115], v[64:79]
  ds_read_b128 v[144:147], v14 offset:2048
  ds_read_b64_tr_b16 v[148:149], v15 offset:4096
  ds_read_b64_tr_b16 v[150:151], v15 offset:5120
  s_waitcnt lgkmcnt(9)
  v_mfma_f32_32x32x16_bf16 v[64:79], v[124:127], v[120:123], v[64:79]
  ds_read_b128 v[152:155], v14 offset:3072
  ds_read_b64_tr_b16 v[156:157], v15 offset:6144
  ds_read_b64_tr_b16 v[158:159], v15 offset:7168
  s_barrier
  v_add_u32 v14, 131072, v11
  v_add_u32 v15, 8192, v12
  s_waitcnt lgkmcnt(9)
  v_mfma_f32_32x32x16_bf16 v[64:79], v[132:135], v[128:131], v[64:79]
  ds_read_b128 v[96:99], v14 offset:0
  ds_read_b64_tr_b16 v[100:101], v15 offset:0
  ds_read_b64_tr_b16 v[102:103], v15 offset:1024
  s_waitcnt lgkmcnt(9)
  v_mfma_f32_32x32x16_bf16 v[64:79], v[140:143], v[136:139], v[64:79]
  ds_read_b128 v[104:107], v14 offset:1024
  ds_read_b64_tr_b16 v[108:109], v15 offset:2048
  ds_read_b64_tr_b16 v[110:111], v15 offset:3072
  s_waitcnt lgkmcnt(9)
  v_mfma_f32_32x32x16_bf16 v[64:79], v[148:151], v[144:147], v[64:79]
  ds_read_b128 v[112:115], v14 offset:2048
  ds_read_b64_tr_b16 v[116:117], v15 offset:4096
  ds_read_b64_tr_b16 v[118:119], v15 offset:5120
  s_waitcnt lgkmcnt(9)
  v_mfma_f32_32x32x16_bf16 v[64:79], v[156:159], v[152:155], v[64:79]
  ds_read_b128 v[120:123], v14 offset:3072
  ds_read_b64_tr_b16 v[124:125], v15 offset:6144
  ds_read_b64_tr_b16 v[126:127], v15 offset:7168
  s_barrier
  v_add_u32 v14, 139264, v11
  v_add_u32 v15, 16384, v12
  s_waitcnt lgkmcnt(9)
  v_mfma_f32_32x32x16_bf16 v[64:79], v[100:103], v[96:99], v[64:79]
  ds_read_b128 v[128:131], v14 offset:0
  ds_read_b64_tr_b16 v[132:133], v15 offset:0
  ds_read_b64_tr_b16 v[134:135], v15 offset:1024
  s_waitcnt lgkmcnt(9)
  v_mfma_f32_32x32x16_bf16 v[64:79], v[108:111], v[104:107], v[64:79]
  ds_read_b128 v[136:139], v14 offset:1024
  ds_read_b64_tr_b16 v[140:141], v15 offset:2048
  ds_read_b64_tr_b16 v[142:143], v15 offset:3072
  s_waitcnt lgkmcnt(9)
  v_mfma_f32_32x32x16_bf16 v[64:79], v[116:119], v[112:115], v[64:79]
  ds_read_b128 v[144:147], v14 offset:2048
  ds_read_b64_tr_b16 v[148:149], v15 offset:4096
  ds_read_b64_tr_b16 v[150:151], v15 offset:5120
  s_waitcnt lgkmcnt(9)
  v_mfma_f32_32x32x16_bf16 v[64:79], v[124:127], v[120:123], v[64:79]
  ds_read_b128 v[152:155], v14 offset:3072
  ds_read_b64_tr_b16 v[156:157], v15 offset:6144
  ds_read_b64_tr_b16 v[158:159], v15 offset:7168
  s_barrier
  v_add_u32 v14, 147456, v11
  v_add_u32 v15, 24576, v12
  s_waitcnt lgkmcnt(9)
  v_mfma_f32_32x32x16_bf16 v[64:79], v[132:135], v[128:131], v[64:79]
  ds_read_b128 v[96:99], v14 offset:0
  ds_read_b64_tr_b16 v[100:101], v15 offset:0
  ds_read_b64_tr_b16 v[102:103], v15 offset:1024
  s_waitcnt lgkmcnt(9)
  v_mfma_f32_32x32x16_bf16 v[64:79], v[140:143], v[136:139], v[64:79]
  ds_read_b128 v[104:107], v14 offset:1024
  ds_read_b64_tr_b16 v[108:109], v15 offset:2048
  ds_read_b64_tr_b16 v[110:111], v15 offset:3072
  s_waitcnt lgkmcnt(9)
  v_mfma_f32_32x32x16_bf16 v[64:79], v[148:151], v[144:147], v[64:79]
  ds_read_b128 v[112:115], v14 offset:2048
  ds_read_b64_tr_b16 v[116:117], v15 offset:4096
  ds_read_b64_tr_b16 v[118:119], v15 offset:5120
  s_waitcnt lgkmcnt(9)
  v_mfma_f32_32x32x16_bf16 v[64:79], v[156:159], v[152:155], v[64:79]
  ds_read_b128 v[120:123], v14 offset:3072
  ds_read_b64_tr_b16 v[124:125], v15 offset:6144
  ds_read_b64_tr_b16 v[126:127], v15 offset:7168
  s_barrier
  v_add_u32 v14, 155648, v11
  v_add_u32 v15, 32768, v12
  s_waitcnt lgkmcnt(9)
  v_mfma_f32_32x32x16_bf16 v[64:79], v[100:103], v[96:99], v[64:79]
  ds_read_b128 v[128:131], v14 offset:0
  ds_read_b64_tr_b16 v[132:133], v15 offset:0
  ds_read_b64_tr_b16 v[134:135], v15 offset:1024
  s_waitcnt lgkmcnt(9)
  v_mfma_f32_32x32x16_bf16 v[64:79], v[108:111], v[104:107], v[64:79]
  ds_read_b128 v[136:139], v14 offset:1024
  ds_read_b64_tr_b16 v[140:141], v15 offset:2048
  ds_read_b64_tr_b16 v[142:143], v15 offset:3072
  s_waitcnt lgkmcnt(9)
  v_mfma_f32_32x32x16_bf16 v[64:79], v[116:119], v[112:115], v[64:79]
  ds_read_b128 v[144:147], v14 offset:2048
  ds_read_b64_tr_b16 v[148:149], v15 offset:4096
  ds_read_b64_tr_b16 v[150:151], v15 offset:5120
  s_waitcnt lgkmcnt(9)
  v_mfma_f32_32x32x16_bf16 v[64:79], v[124:127], v[120:123], v[64:79]
  ds_read_b128 v[152:155], v14 offset:3072
  ds_read_b64_tr_b16 v[156:157], v15 offset:6144
  ds_read_b64_tr_b16 v[158:159], v15 offset:7168
  s_barrier
  v_add_u32 v14, 122880, v11
  v_add_u32 v15, 40960, v12
  s_waitcnt lgkmcnt(9)
  v_mfma_f32_32x32x16_bf16 v[64:79], v[132:135], v[128:131], v[64:79]
  ds_read_b128 v[96:99], v14 offset:0
  ds_read_b64_tr_b16 v[100:101], v15 offset:0
  ds_read_b64_tr_b16 v[102:103], v15 offset:1024
  s_waitcnt lgkmcnt(9)
  v_mfma_f32_32x32x16_bf16 v[64:79], v[140:143], v[136:139], v[64:79]
  ds_read_b128 v[104:107], v14 offset:1024
  ds_read_b64_tr_b16 v[108:109], v15 offset:2048
  ds_read_b64_tr_b16 v[110:111], v15 offset:3072
  s_waitcnt lgkmcnt(9)
  v_mfma_f32_32x32x16_bf16 v[64:79], v[148:151], v[144:147], v[64:79]
  ds_read_b128 v[112:115], v14 offset:2048
  ds_read_b64_tr_b16 v[116:117], v15 offset:4096
  ds_read_b64_tr_b16 v[118:119], v15 offset:5120
  s_waitcnt lgkmcnt(9)
  v_mfma_f32_32x32x16_bf16 v[64:79], v[156:159], v[152:155], v[64:79]
  ds_read_b128 v[120:123], v14 offset:3072
  ds_read_b64_tr_b16 v[124:125], v15 offset:6144
  ds_read_b64_tr_b16 v[126:127], v15 offset:7168
  s_barrier
  v_add_u32 v14, 131072, v11
  v_add_u32 v15, 49152, v12
  s_waitcnt lgkmcnt(9)
  v_mfma_f32_32x32x16_bf16 v[64:79], v[100:103], v[96:99], v[64:79]
  ds_read_b128 v[128:131], v14 offset:0
  ds_read_b64_tr_b16 v[132:133], v15 offset:0
  ds_read_b64_tr_b16 v[134:135], v15 offset:1024
  s_waitcnt lgkmcnt(9)
  v_mfma_f32_32x32x16_bf16 v[64:79], v[108:111], v[104:107], v[64:79]
  ds_read_b128 v[136:139], v14 offset:1024
  ds_read_b64_tr_b16 v[140:141], v15 offset:2048
  ds_read_b64_tr_b16 v[142:143], v15 offset:3072
  s_waitcnt lgkmcnt(9)
  v_mfma_f32_32x32x16_bf16 v[64:79], v[116:119], v[112:115], v[64:79]
  ds_read_b128 v[144:147], v14 offset:2048
  ds_read_b64_tr_b16 v[148:149], v15 offset:4096
  ds_read_b64_tr_b16 v[150:151], v15 offset:5120
  s_waitcnt lgkmcnt(9)
  v_mfma_f32_32x32x16_bf16 v[64:79], v[124:127], v[120:123], v[64:79]
  ds_read_b128 v[152:155], v14 offset:3072
  ds_read_b64_tr_b16 v[156:157], v15 offset:6144
  ds_read_b64_tr_b16 v[158:159], v15 offset:7168
  s_barrier
  v_add_u32 v14, 139264, v11
  v_add_u32 v15, 57344, v12
  s_waitcnt lgkmcnt(9)
  v_mfma_f32_32x32x16_bf16 v[64:79], v[132:135], v[128:131], v[64:79]
  ds_read_b128 v[96:99], v14 offset:0
  ds_read_b64_tr_b16 v[100:101], v15 offset:0
  ds_read_b64_tr_b16 v[102:103], v15 offset:1024
  s_waitcnt lgkmcnt(9)
  v_mfma_f32_32x32x16_bf16 v[64:79], v[140:143], v[136:139], v[64:79]
  ds_read_b128 v[104:107], v14 offset:1024
  ds_read_b64_tr_b16 v[108:109], v15 offset:2048
  ds_read_b64_tr_b16 v[110:111], v15 offset:3072
  s_waitcnt lgkmcnt(9)
  v_mfma_f32_32x32x16_bf16 v[64:79], v[148:151], v[144:147], v[64:79]
  ds_read_b128 v[112:115], v14 offset:2048
  ds_read_b64_tr_b16 v[116:117], v15 offset:4096
  ds_read_b64_tr_b16 v[118:119], v15 offset:5120
  s_waitcnt lgkmcnt(9)
  v_mfma_f32_32x32x16_bf16 v[64:79], v[156:159], v[152:155], v[64:79]
  ds_read_b128 v[120:123], v14 offset:3072
  ds_read_b64_tr_b16 v[124:125], v15 offset:6144
  ds_read_b64_tr_b16 v[126:127], v15 offset:7168
  s_barrier
  v_add_u32 v14, 147456, v11
  v_add_u32 v15, 65536, v12
  s_waitcnt lgkmcnt(9)
  v_mfma_f32_32x32x16_bf16 v[64:79], v[100:103], v[96:99], v[64:79]
  ds_read_b128 v[128:131], v14 offset:0
  ds_read_b64_tr_b16 v[132:133], v15 offset:0
  ds_read_b64_tr_b16 v[134:135], v15 offset:1024
  s_waitcnt lgkmcnt(9)
  v_mfma_f32_32x32x16_bf16 v[64:79], v[108:111], v[104:107], v[64:79]
  ds_read_b128 v[136:139], v14 offset:1024
  ds_read_b64_tr_b16 v[140:141], v15 offset:2048
  ds_read_b64_tr_b16 v[142:143], v15 offset:3072
  s_waitcnt lgkmcnt(9)
  v_mfma_f32_32x32x16_bf16 v[64:79], v[116:119], v[112:115], v[64:79]
  ds_read_b128 v[144:147], v14 offset:2048
  ds_read_b64_tr_b16 v[148:149], v15 offset:4096
  ds_read_b64_tr_b16 v[150:151], v15 offset:5120
  s_waitcnt lgkmcnt(9)
  v_mfma_f32_32x32x16_bf16 v[64:79], v[124:127], v[120:123], v[64:79]
  ds_read_b128 v[152:155], v14 offset:3072
  ds_read_b64_tr_b16 v[156:157], v15 offset:6144
  ds_read_b64_tr_b16 v[158:159], v15 offset:7168
  s_barrier
  v_add_u32 v14, 155648, v11
  v_add_u32 v15, 73728, v12
  s_waitcnt lgkmcnt(9)
  v_mfma_f32_32x32x16_bf16 v[64:79], v[132:135], v[128:131], v[64:79]
  ds_read_b128 v[96:99], v14 offset:0
  ds_read_b64_tr_b16 v[100:101], v15 offset:0
  ds_read_b64_tr_b16 v[102:103], v15 offset:1024
  s_waitcnt lgkmcnt(9)
  v_mfma_f32_32x32x16_bf16 v[64:79], v[140:143], v[136:139], v[64:79]
  ds_read_b128 v[104:107], v14 offset:1024
  ds_read_b64_tr_b16 v[108:109], v15 offset:2048
  ds_read_b64_tr_b16 v[110:111], v15 offset:3072
  s_waitcnt lgkmcnt(9)
  v_mfma_f32_32x32x16_bf16 v[64:79], v[148:151], v[144:147], v[64:79]
  ds_read_b128 v[112:115], v14 offset:2048
  ds_read_b64_tr_b16 v[116:117], v15 offset:4096
  ds_read_b64_tr_b16 v[118:119], v15 offset:5120
  s_waitcnt lgkmcnt(9)
  v_mfma_f32_32x32x16_bf16 v[64:79], v[156:159], v[152:155], v[64:79]
  ds_read_b128 v[120:123], v14 offset:3072
  ds_read_b64_tr_b16 v[124:125], v15 offset:6144
  ds_read_b64_tr_b16 v[126:127], v15 offset:7168
  s_barrier
  v_add_u32 v14, 122880, v11
  v_add_u32 v15, 81920, v12
  s_waitcnt lgkmcnt(9)
  v_mfma_f32_32x32x16_bf16 v[64:79], v[100:103], v[96:99], v[64:79]
  ds_read_b128 v[128:131], v14 offset:0
  ds_read_b64_tr_b16 v[132:133], v15 offset:0
  ds_read_b64_tr_b16 v[134:135], v15 offset:1024
  s_waitcnt lgkmcnt(9)
  v_mfma_f32_32x32x16_bf16 v[64:79], v[108:111], v[104:107], v[64:79]
  ds_read_b128 v[136:139], v14 offset:1024
  ds_read_b64_tr_b16 v[140:141], v15 offset:2048
  ds_read_b64_tr_b16 v[142:143], v15 offset:3072
  s_waitcnt lgkmcnt(9)
  v_mfma_f32_32x32x16_bf16 v[64:79], v[116:119], v[112:115], v[64:79]
  ds_read_b128 v[144:147], v14 offset:2048
  ds_read_b64_tr_b16 v[148:149], v15 offset:4096
  ds_read_b64_tr_b16 v[150:151], v15 offset:5120
  s_waitcnt lgkmcnt(9)
  v_mfma_f32_32x32x16_bf16 v[64:79], v[124:127], v[120:123], v[64:79]
  ds_read_b128 v[152:155], v14 offset:3072
  ds_read_b64_tr_b16 v[156:157], v15 offset:6144
  ds_read_b64_tr_b16 v[158:159], v15 offset:7168
  s_barrier
  v_add_u32 v14, 131072, v11
  v_add_u32 v15, 90112, v12
  s_waitcnt lgkmcnt(9)
  v_mfma_f32_32x32x16_bf16 v[64:79], v[132:135], v[128:131], v[64:79]
  ds_read_b128 v[96:99], v14 offset:0
  ds_read_b64_tr_b16 v[100:101], v15 offset:0
  ds_read_b64_tr_b16 v[102:103], v15 offset:1024
  s_waitcnt lgkmcnt(9)
  v_mfma_f32_32x32x16_bf16 v[64:79], v[140:143], v[136:139], v[64:79]
  ds_read_b128 v[104:107], v14 offset:1024
  ds_read_b64_tr_b16 v[108:109], v15 offset:2048
  ds_read_b64_tr_b16 v[110:111], v15 offset:3072
  s_waitcnt lgkmcnt(9)
  v_mfma_f32_32x32x16_bf16 v[64:79], v[148:151], v[144:147], v[64:79]
  ds_read_b128 v[112:115], v14 offset:2048
  ds_read_b64_tr_b16 v[116:117], v15 offset:4096
  ds_read_b64_tr_b16 v[118:119], v15 offset:5120
  s_waitcnt lgkmcnt(9)
  v_mfma_f32_32x32x16_bf16 v[64:79], v[156:159], v[152:155], v[64:79]
  ds_read_b128 v[120:123], v14 offset:3072
  ds_read_b64_tr_b16 v[124:125], v15 offset:6144
  ds_read_b64_tr_b16 v[126:127], v15 offset:7168
  s_barrier
  v_add_u32 v14, 139264, v11
  v_add_u32 v15, 98304, v12
  s_waitcnt lgkmcnt(9)
  v_mfma_f32_32x32x16_bf16 v[64:79], v[100:103], v[96:99], v[64:79]
  ds_read_b128 v[128:131], v14 offset:0
  ds_read_b64_tr_b16 v[132:133], v15 offset:0
  ds_read_b64_tr_b16 v[134:135], v15 offset:1024
  s_waitcnt lgkmcnt(9)
  v_mfma_f32_32x32x16_bf16 v[64:79], v[108:111], v[104:107], v[64:79]
  ds_read_b128 v[136:139], v14 offset:1024
  ds_read_b64_tr_b16 v[140:141], v15 offset:2048
  ds_read_b64_tr_b16 v[142:143], v15 offset:3072
  s_waitcnt lgkmcnt(9)
  v_mfma_f32_32x32x16_bf16 v[64:79], v[116:119], v[112:115], v[64:79]
  ds_read_b128 v[144:147], v14 offset:2048
  ds_read_b64_tr_b16 v[148:149], v15 offset:4096
  ds_read_b64_tr_b16 v[150:151], v15 offset:5120
  s_waitcnt lgkmcnt(9)
  v_mfma_f32_32x32x16_bf16 v[64:79], v[124:127], v[120:123], v[64:79]
  ds_read_b128 v[152:155], v14 offset:3072
  ds_read_b64_tr_b16 v[156:157], v15 offset:6144
  ds_read_b64_tr_b16 v[158:159], v15 offset:7168
  s_barrier
  v_add_u32 v14, 147456, v11
  v_add_u32 v15, 106496, v13
  s_waitcnt lgkmcnt(9)
  v_mfma_f32_32x32x16_bf16 v[64:79], v[132:135], v[128:131], v[64:79]
  ds_read_b128 v[96:99], v14 offset:0
  ds_read_b128 v[100:103], v15
  s_waitcnt lgkmcnt(8)
  v_mfma_f32_32x32x16_bf16 v[64:79], v[140:143], v[136:139], v[64:79]
  ds_read_b128 v[104:107], v14 offset:1024
  v_xor_b32 v58, 32, v15
  ds_read_b128 v[108:111], v58
  s_waitcnt lgkmcnt(7)
  v_mfma_f32_32x32x16_bf16 v[64:79], v[148:151], v[144:147], v[64:79]
  ds_read_b128 v[112:115], v14 offset:2048
  v_xor_b32 v58, 64, v15
  ds_read_b128 v[116:119], v58
  s_waitcnt lgkmcnt(6)
  v_mfma_f32_32x32x16_bf16 v[64:79], v[156:159], v[152:155], v[64:79]
  ds_read_b128 v[120:123], v14 offset:3072
  v_xor_b32 v58, 96, v15
  ds_read_b128 v[124:127], v58
  s_barrier
  v_add_u32 v14, 155648, v11
  v_add_u32 v15, 114688, v13
  s_waitcnt lgkmcnt(6)
  v_mfma_f32_32x32x16_bf16 v[80:95], v[100:103], v[96:99], 0
  ds_read_b128 v[128:131], v14 offset:0
  ds_read_b128 v[132:135], v15
  s_waitcnt lgkmcnt(6)
  v_mfma_f32_32x32x16_bf16 v[80:95], v[108:111], v[104:107], v[80:95]
  ds_read_b128 v[136:139], v14 offset:1024
  v_xor_b32 v58, 32, v15
  ds_read_b128 v[140:143], v58
  s_waitcnt lgkmcnt(6)
  v_mfma_f32_32x32x16_bf16 v[80:95], v[116:119], v[112:115], v[80:95]
  ds_read_b128 v[144:147], v14 offset:2048
  v_xor_b32 v58, 64, v15
  ds_read_b128 v[148:151], v58
  s_waitcnt lgkmcnt(6)
  v_mfma_f32_32x32x16_bf16 v[80:95], v[124:127], v[120:123], v[80:95]
  ds_read_b128 v[152:155], v14 offset:3072
  v_xor_b32 v58, 96, v15
  ds_read_b128 v[156:159], v58
  s_barrier
  v_add_u32 v14, 122880, v11
  v_add_u32 v15, 0, v13
  s_waitcnt lgkmcnt(6)
  v_mfma_f32_32x32x16_bf16 v[80:95], v[132:135], v[128:131], v[80:95]
  ds_read_b128 v[96:99], v14 offset:0
  ds_read_b128 v[100:103], v15
  v_cvt_pk_bf16_f32 v53, v64, v65
  v_lshlrev_b32 v51, 16, v53
  v_and_b32 v52, 0xffff0000, v53
  v_mul_f32 v54, 0xbfb8aa3b, v51
  s_waitcnt lgkmcnt(6)
  v_mfma_f32_32x32x16_bf16 v[80:95], v[140:143], v[136:139], v[80:95]
  ds_read_b128 v[104:107], v14 offset:1024
  v_xor_b32 v58, 32, v15
  ds_read_b128 v[108:111], v58
  v_mul_f32 v55, 0xbfb8aa3b, v52
  v_exp_f32 v54, v54
  v_exp_f32 v55, v55
  v_add_f32 v54, 1.0, v54
  s_waitcnt lgkmcnt(6)
  v_mfma_f32_32x32x16_bf16 v[80:95], v[148:151], v[144:147], v[80:95]
  ds_read_b128 v[112:115], v14 offset:2048
  v_xor_b32 v58, 64, v15
  ds_read_b128 v[116:119], v58
  v_add_f32 v55, 1.0, v55
  v_rcp_f32 v54, v54
  v_rcp_f32 v55, v55
  v_mul_f32 v51, v51, v54
  s_waitcnt lgkmcnt(6)
  v_mfma_f32_32x32x16_bf16 v[80:95], v[156:159], v[152:155], v[80:95]
  ds_read_b128 v[120:123], v14 offset:3072
  v_xor_b32 v58, 96, v15
  ds_read_b128 v[124:127], v58
  v_mul_f32 v52, v52, v55
  v_cvt_pk_bf16_f32 v53, v51, v52
  v_lshlrev_b32 v176, 16, v53
  v_and_b32 v177, 0xffff0000, v53
  s_barrier
  v_add_u32 v14, 131072, v11
  v_add_u32 v15, 8192, v13
  s_waitcnt lgkmcnt(6)
  v_mfma_f32_32x32x16_bf16 v[80:95], v[100:103], v[96:99], v[80:95]
  ds_read_b128 v[128:131], v14 offset:0
  ds_read_b128 v[132:135], v15
  v_cvt_pk_bf16_f32 v53, v66, v67
  v_lshlrev_b32 v51, 16, v53
  v_and_b32 v52, 0xffff0000, v53
  v_mul_f32 v54, 0xbfb8aa3b, v51
  s_waitcnt lgkmcnt(6)
  v_mfma_f32_32x32x16_bf16 v[80:95], v[108:111], v[104:107], v[80:95]
  ds_read_b128 v[136:139], v14 offset:1024
  v_xor_b32 v58, 32, v15
  ds_read_b128 v[140:143], v58
  v_mul_f32 v55, 0xbfb8aa3b, v52
  v_exp_f32 v54, v54
  v_exp_f32 v55, v55
  v_add_f32 v54, 1.0, v54
  s_waitcnt lgkmcnt(6)
  v_mfma_f32_32x32x16_bf16 v[80:95], v[116:119], v[112:115], v[80:95]
  ds_read_b128 v[144:147], v14 offset:2048
  v_xor_b32 v58, 64, v15
  ds_read_b128 v[148:151], v58
  v_add_f32 v55, 1.0, v55
  v_rcp_f32 v54, v54
  v_rcp_f32 v55, v55
  v_mul_f32 v51, v51, v54
  s_waitcnt lgkmcnt(6)
  v_mfma_f32_32x32x16_bf16 v[80:95], v[124:127], v[120:123], v[80:95]
  ds_read_b128 v[152:155], v14 offset:3072
  v_xor_b32 v58, 96, v15
  ds_read_b128 v[156:159], v58
  v_mul_f32 v52, v52, v55
  v_cvt_pk_bf16_f32 v53, v51, v52
  v_lshlrev_b32 v178, 16, v53
  v_and_b32 v179, 0xffff0000, v53
  s_barrier
  v_add_u32 v14, 139264, v11
  v_add_u32 v15, 16384, v13
  s_waitcnt lgkmcnt(6)
  v_mfma_f32_32x32x16_bf16 v[80:95], v[132:135], v[128:131], v[80:95]
  ds_read_b128 v[96:99], v14 offset:0
  ds_read_b128 v[100:103], v15
  v_cvt_pk_bf16_f32 v53, v68, v69
  v_lshlrev_b32 v51, 16, v53
  v_and_b32 v52, 0xffff0000, v53
  v_mul_f32 v54, 0xbfb8aa3b, v51
  s_waitcnt lgkmcnt(6)
  v_mfma_f32_32x32x16_bf16 v[80:95], v[140:143], v[136:139], v[80:95]
  ds_read_b128 v[104:107], v14 offset:1024
  v_xor_b32 v58, 32, v15
  ds_read_b128 v[108:111], v58
  v_mul_f32 v55, 0xbfb8aa3b, v52
  v_exp_f32 v54, v54
  v_exp_f32 v55, v55
  v_add_f32 v54, 1.0, v54
  s_waitcnt lgkmcnt(6)
  v_mfma_f32_32x32x16_bf16 v[80:95], v[148:151], v[144:147], v[80:95]
  ds_read_b128 v[112:115], v14 offset:2048
  v_xor_b32 v58, 64, v15
  ds_read_b128 v[116:119], v58
  v_add_f32 v55, 1.0, v55
  v_rcp_f32 v54, v54
  v_rcp_f32 v55, v55
  v_mul_f32 v51, v51, v54
  s_waitcnt lgkmcnt(6)
  v_mfma_f32_32x32x16_bf16 v[80:95], v[156:159], v[152:155], v[80:95]
  ds_read_b128 v[120:123], v14 offset:3072
  v_xor_b32 v58, 96, v15
  ds_read_b128 v[124:127], v58
  v_mul_f32 v52, v52, v55
  v_cvt_pk_bf16_f32 v53, v51, v52
  v_lshlrev_b32 v180, 16, v53
  v_and_b32 v181, 0xffff0000, v53
  s_barrier
  v_add_u32 v14, 147456, v11
  v_add_u32 v15, 24576, v13
  s_waitcnt lgkmcnt(6)
  v_mfma_f32_32x32x16_bf16 v[80:95], v[100:103], v[96:99], v[80:95]
  ds_read_b128 v[128:131], v14 offset:0
  ds_read_b128 v[132:135], v15
  v_cvt_pk_bf16_f32 v53, v70, v71
  v_lshlrev_b32 v51, 16, v53
  v_and_b32 v52, 0xffff0000, v53
  v_mul_f32 v54, 0xbfb8aa3b, v51
  s_waitcnt lgkmcnt(6)
  v_mfma_f32_32x32x16_bf16 v[80:95], v[108:111], v[104:107], v[80:95]
  ds_read_b128 v[136:139], v14 offset:1024
  v_xor_b32 v58, 32, v15
  ds_read_b128 v[140:143], v58
  v_mul_f32 v55, 0xbfb8aa3b, v52
  v_exp_f32 v54, v54
  v_exp_f32 v55, v55
  v_add_f32 v54, 1.0, v54
  s_waitcnt lgkmcnt(6)
  v_mfma_f32_32x32x16_bf16 v[80:95], v[116:119], v[112:115], v[80:95]
  ds_read_b128 v[144:147], v14 offset:2048
  v_xor_b32 v58, 64, v15
  ds_read_b128 v[148:151], v58
  v_add_f32 v55, 1.0, v55
  v_rcp_f32 v54, v54
  v_rcp_f32 v55, v55
  v_mul_f32 v51, v51, v54
  s_waitcnt lgkmcnt(6)
  v_mfma_f32_32x32x16_bf16 v[80:95], v[124:127], v[120:123], v[80:95]
  ds_read_b128 v[152:155], v14 offset:3072
  v_xor_b32 v58, 96, v15
  ds_read_b128 v[156:159], v58
  v_mul_f32 v52, v52, v55
  v_cvt_pk_bf16_f32 v53, v51, v52
  v_lshlrev_b32 v182, 16, v53
  v_and_b32 v183, 0xffff0000, v53
  s_barrier
  v_add_u32 v14, 155648, v11
  v_add_u32 v15, 32768, v13
  s_waitcnt lgkmcnt(6)
  v_mfma_f32_32x32x16_bf16 v[80:95], v[132:135], v[128:131], v[80:95]
  ds_read_b128 v[96:99], v14 offset:0
  ds_read_b128 v[100:103], v15
  v_cvt_pk_bf16_f32 v53, v72, v73
  v_lshlrev_b32 v51, 16, v53
  v_and_b32 v52, 0xffff0000, v53
  v_mul_f32 v54, 0xbfb8aa3b, v51
  s_waitcnt lgkmcnt(6)
  v_mfma_f32_32x32x16_bf16 v[80:95], v[140:143], v[136:139], v[80:95]
  ds_read_b128 v[104:107], v14 offset:1024
  v_xor_b32 v58, 32, v15
  ds_read_b128 v[108:111], v58
  v_mul_f32 v55, 0xbfb8aa3b, v52
  v_exp_f32 v54, v54
  v_exp_f32 v55, v55
  v_add_f32 v54, 1.0, v54
  s_waitcnt lgkmcnt(6)
  v_mfma_f32_32x32x16_bf16 v[80:95], v[148:151], v[144:147], v[80:95]
  ds_read_b128 v[112:115], v14 offset:2048
  v_xor_b32 v58, 64, v15
  ds_read_b128 v[116:119], v58
  v_add_f32 v55, 1.0, v55
  v_rcp_f32 v54, v54
  v_rcp_f32 v55, v55
  v_mul_f32 v51, v51, v54
  s_waitcnt lgkmcnt(6)
  v_mfma_f32_32x32x16_bf16 v[80:95], v[156:159], v[152:155], v[80:95]
  ds_read_b128 v[120:123], v14 offset:3072
  v_xor_b32 v58, 96, v15
  ds_read_b128 v[124:127], v58
  v_mul_f32 v52, v52, v55
  v_cvt_pk_bf16_f32 v53, v51, v52
  v_lshlrev_b32 v184, 16, v53
  v_and_b32 v185, 0xffff0000, v53
  s_barrier
  v_add_u32 v14, 122880, v11
  v_add_u32 v15, 40960, v13
  s_waitcnt lgkmcnt(6)
  v_mfma_f32_32x32x16_bf16 v[80:95], v[100:103], v[96:99], v[80:95]
  ds_read_b128 v[128:131], v14 offset:0
  ds_read_b128 v[132:135], v15
  v_cvt_pk_bf16_f32 v53, v74, v75
  v_lshlrev_b32 v51, 16, v53
  v_and_b32 v52, 0xffff0000, v53
  v_mul_f32 v54, 0xbfb8aa3b, v51
  s_waitcnt lgkmcnt(6)
  v_mfma_f32_32x32x16_bf16 v[80:95], v[108:111], v[104:107], v[80:95]
  ds_read_b128 v[136:139], v14 offset:1024
  v_xor_b32 v58, 32, v15
  ds_read_b128 v[140:143], v58
  v_mul_f32 v55, 0xbfb8aa3b, v52
  v_exp_f32 v54, v54
  v_exp_f32 v55, v55
  v_add_f32 v54, 1.0, v54
  s_waitcnt lgkmcnt(6)
  v_mfma_f32_32x32x16_bf16 v[80:95], v[116:119], v[112:115], v[80:95]
  ds_read_b128 v[144:147], v14 offset:2048
  v_xor_b32 v58, 64, v15
  ds_read_b128 v[148:151], v58
  v_add_f32 v55, 1.0, v55
  v_rcp_f32 v54, v54
  v_rcp_f32 v55, v55
  v_mul_f32 v51, v51, v54
  s_waitcnt lgkmcnt(6)
  v_mfma_f32_32x32x16_bf16 v[80:95], v[124:127], v[120:123], v[80:95]
  ds_read_b128 v[152:155], v14 offset:3072
  v_xor_b32 v58, 96, v15
  ds_read_b128 v[156:159], v58
  v_mul_f32 v52, v52, v55
  v_cvt_pk_bf16_f32 v53, v51, v52
  v_lshlrev_b32 v186, 16, v53
  v_and_b32 v187, 0xffff0000, v53
  s_barrier
  v_add_u32 v14, 131072, v11
  v_add_u32 v15, 49152, v13
  s_waitcnt lgkmcnt(6)
  v_mfma_f32_32x32x16_bf16 v[80:95], v[132:135], v[128:131], v[80:95]
  ds_read_b128 v[96:99], v14 offset:0
  ds_read_b128 v[100:103], v15
  v_cvt_pk_bf16_f32 v53, v76, v77
  v_lshlrev_b32 v51, 16, v53
  v_and_b32 v52, 0xffff0000, v53
  v_mul_f32 v54, 0xbfb8aa3b, v51
  s_waitcnt lgkmcnt(6)
  v_mfma_f32_32x32x16_bf16 v[80:95], v[140:143], v[136:139], v[80:95]
  ds_read_b128 v[104:107], v14 offset:1024
  v_xor_b32 v58, 32, v15
  ds_read_b128 v[108:111], v58
  v_mul_f32 v55, 0xbfb8aa3b, v52
  v_exp_f32 v54, v54
  v_exp_f32 v55, v55
  v_add_f32 v54, 1.0, v54
  s_waitcnt lgkmcnt(6)
  v_mfma_f32_32x32x16_bf16 v[80:95], v[148:151], v[144:147], v[80:95]
  ds_read_b128 v[112:115], v14 offset:2048
  v_xor_b32 v58, 64, v15
  ds_read_b128 v[116:119], v58
  v_add_f32 v55, 1.0, v55
  v_rcp_f32 v54, v54
  v_rcp_f32 v55, v55
  v_mul_f32 v51, v51, v54
  s_waitcnt lgkmcnt(6)
  v_mfma_f32_32x32x16_bf16 v[80:95], v[156:159], v[152:155], v[80:95]
  ds_read_b128 v[120:123], v14 offset:3072
  v_xor_b32 v58, 96, v15
  ds_read_b128 v[124:127], v58
  v_mul_f32 v52, v52, v55
  v_cvt_pk_bf16_f32 v53, v51, v52
  v_lshlrev_b32 v188, 16, v53
  v_and_b32 v189, 0xffff0000, v53
  s_barrier
  v_add_u32 v14, 139264, v11
  v_add_u32 v15, 57344, v13
  s_waitcnt lgkmcnt(6)
  v_mfma_f32_32x32x16_bf16 v[80:95], v[100:103], v[96:99], v[80:95]
  ds_read_b128 v[128:131], v14 offset:0
  ds_read_b128 v[132:135], v15
  v_cvt_pk_bf16_f32 v53, v78, v79
  v_lshlrev_b32 v51, 16, v53
  v_and_b32 v52, 0xffff0000, v53
  v_mul_f32 v54, 0xbfb8aa3b, v51
  s_waitcnt lgkmcnt(6)
  v_mfma_f32_32x32x16_bf16 v[80:95], v[108:111], v[104:107], v[80:95]
  ds_read_b128 v[136:139], v14 offset:1024
  v_xor_b32 v58, 32, v15
  ds_read_b128 v[140:143], v58
  v_mul_f32 v55, 0xbfb8aa3b, v52
  v_exp_f32 v54, v54
  v_exp_f32 v55, v55
  v_add_f32 v54, 1.0, v54
  s_waitcnt lgkmcnt(6)
  v_mfma_f32_32x32x16_bf16 v[80:95], v[116:119], v[112:115], v[80:95]
  ds_read_b128 v[144:147], v14 offset:2048
  v_xor_b32 v58, 64, v15
  ds_read_b128 v[148:151], v58
  v_add_f32 v55, 1.0, v55
  v_rcp_f32 v54, v54
  v_rcp_f32 v55, v55
  v_mul_f32 v51, v51, v54
  s_waitcnt lgkmcnt(6)
  v_mfma_f32_32x32x16_bf16 v[80:95], v[124:127], v[120:123], v[80:95]
  ds_read_b128 v[152:155], v14 offset:3072
  v_xor_b32 v58, 96, v15
  ds_read_b128 v[156:159], v58
  v_mul_f32 v52, v52, v55
  v_cvt_pk_bf16_f32 v53, v51, v52
  v_lshlrev_b32 v190, 16, v53
  v_and_b32 v191, 0xffff0000, v53
  s_barrier
  v_add_u32 v14, 147456, v11
  v_add_u32 v15, 65536, v13
  s_waitcnt lgkmcnt(6)
  v_mfma_f32_32x32x16_bf16 v[80:95], v[132:135], v[128:131], v[80:95]
  ds_read_b128 v[96:99], v14 offset:0
  ds_read_b128 v[100:103], v15
  s_waitcnt lgkmcnt(6)
  v_mfma_f32_32x32x16_bf16 v[80:95], v[140:143], v[136:139], v[80:95]
  ds_read_b128 v[104:107], v14 offset:1024
  v_xor_b32 v58, 32, v15
  ds_read_b128 v[108:111], v58
  s_waitcnt lgkmcnt(6)
  v_mfma_f32_32x32x16_bf16 v[80:95], v[148:151], v[144:147], v[80:95]
  ds_read_b128 v[112:115], v14 offset:2048
  v_xor_b32 v58, 64, v15
  ds_read_b128 v[116:119], v58
  s_waitcnt lgkmcnt(6)
  v_mfma_f32_32x32x16_bf16 v[80:95], v[156:159], v[152:155], v[80:95]
  ds_read_b128 v[120:123], v14 offset:3072
  v_xor_b32 v58, 96, v15
  ds_read_b128 v[124:127], v58
  s_barrier
  v_add_u32 v14, 155648, v11
  v_add_u32 v15, 73728, v13
  s_waitcnt lgkmcnt(6)
  v_mfma_f32_32x32x16_bf16 v[80:95], v[100:103], v[96:99], v[80:95]
  ds_read_b128 v[128:131], v14 offset:0
  ds_read_b128 v[132:135], v15
  s_waitcnt lgkmcnt(6)
  v_mfma_f32_32x32x16_bf16 v[80:95], v[108:111], v[104:107], v[80:95]
  ds_read_b128 v[136:139], v14 offset:1024
  v_xor_b32 v58, 32, v15
  ds_read_b128 v[140:143], v58
  s_waitcnt lgkmcnt(6)
  v_mfma_f32_32x32x16_bf16 v[80:95], v[116:119], v[112:115], v[80:95]
  ds_read_b128 v[144:147], v14 offset:2048
  v_xor_b32 v58, 64, v15
  ds_read_b128 v[148:151], v58
  s_waitcnt lgkmcnt(6)
  v_mfma_f32_32x32x16_bf16 v[80:95], v[124:127], v[120:123], v[80:95]
  ds_read_b128 v[152:155], v14 offset:3072
  v_xor_b32 v58, 96, v15
  ds_read_b128 v[156:159], v58
  s_barrier
  v_add_u32 v14, 122880, v11
  v_add_u32 v15, 81920, v13
  s_waitcnt lgkmcnt(6)
  v_mfma_f32_32x32x16_bf16 v[80:95], v[132:135], v[128:131], v[80:95]
  ds_read_b128 v[96:99], v14 offset:0
  ds_read_b128 v[100:103], v15
  s_waitcnt lgkmcnt(6)
  v_mfma_f32_32x32x16_bf16 v[80:95], v[140:143], v[136:139], v[80:95]
  ds_read_b128 v[104:107], v14 offset:1024
  v_xor_b32 v58, 32, v15
  ds_read_b128 v[108:111], v58
  s_waitcnt lgkmcnt(6)
  v_mfma_f32_32x32x16_bf16 v[80:95], v[148:151], v[144:147], v[80:95]
  ds_read_b128 v[112:115], v14 offset:2048
  v_xor_b32 v58, 64, v15
  ds_read_b128 v[116:119], v58
  s_waitcnt lgkmcnt(6)
  v_mfma_f32_32x32x16_bf16 v[80:95], v[156:159], v[152:155], v[80:95]
  ds_read_b128 v[120:123], v14 offset:3072
  v_xor_b32 v58, 96, v15
  ds_read_b128 v[124:127], v58
  s_barrier
  v_add_u32 v14, 131072, v11
  v_add_u32 v15, 90112, v13
  s_waitcnt lgkmcnt(6)
  v_mfma_f32_32x32x16_bf16 v[80:95], v[100:103], v[96:99], v[80:95]
  ds_read_b128 v[128:131], v14 offset:0
  ds_read_b128 v[132:135], v15
  s_waitcnt lgkmcnt(6)
  v_mfma_f32_32x32x16_bf16 v[80:95], v[108:111], v[104:107], v[80:95]
  ds_read_b128 v[136:139], v14 offset:1024
  v_xor_b32 v58, 32, v15
  ds_read_b128 v[140:143], v58
  s_waitcnt lgkmcnt(6)
  v_mfma_f32_32x32x16_bf16 v[80:95], v[116:119], v[112:115], v[80:95]
  ds_read_b128 v[144:147], v14 offset:2048
  v_xor_b32 v58, 64, v15
  ds_read_b128 v[148:151], v58
  s_waitcnt lgkmcnt(6)
  v_mfma_f32_32x32x16_bf16 v[80:95], v[124:127], v[120:123], v[80:95]
  ds_read_b128 v[152:155], v14 offset:3072
  v_xor_b32 v58, 96, v15
  ds_read_b128 v[156:159], v58
  s_waitcnt lgkmcnt(6)
  v_mfma_f32_32x32x16_bf16 v[80:95], v[132:135], v[128:131], v[80:95]
  s_waitcnt lgkmcnt(4)
  v_mfma_f32_32x32x16_bf16 v[80:95], v[140:143], v[136:139], v[80:95]
  s_waitcnt lgkmcnt(2)
  v_mfma_f32_32x32x16_bf16 v[80:95], v[148:151], v[144:147], v[80:95]
  s_waitcnt lgkmcnt(0)
  v_mfma_f32_32x32x16_bf16 v[80:95], v[156:159], v[152:155], v[80:95]
  s_nop 11
  v_add_f32 v160, v80, v160
  v_add_f32 v161, v81, v161
  v_add_f32 v162, v82, v162
  v_add_f32 v163, v83, v163
  v_add_f32 v164, v84, v164
  v_add_f32 v165, v85, v165
  v_add_f32 v166, v86, v166
  v_add_f32 v167, v87, v167
  v_add_f32 v168, v88, v168
  v_add_f32 v169, v89, v169
  v_add_f32 v170, v90, v170
  v_add_f32 v171, v91, v171
  v_add_f32 v172, v92, v172
  v_add_f32 v173, v93, v173
  v_add_f32 v174, v94, v174
  v_add_f32 v175, v95, v175
  v_fma_f32 v160, v160, v176, v34
  v_fma_f32 v161, v161, v177, v35
  v_fma_f32 v162, v162, v178, v36
  v_fma_f32 v163, v163, v179, v37
  v_fma_f32 v164, v164, v180, v38
  v_fma_f32 v165, v165, v181, v39
  v_fma_f32 v166, v166, v182, v40
  v_fma_f32 v167, v167, v183, v41
  v_fma_f32 v168, v168, v184, v42
  v_fma_f32 v169, v169, v185, v43
  v_fma_f32 v170, v170, v186, v44
  v_fma_f32 v171, v171, v187, v45
  v_fma_f32 v172, v172, v188, v46
  v_fma_f32 v173, v173, v189, v47
  v_fma_f32 v174, v174, v190, v48
  v_fma_f32 v175, v175, v191, v49
  buffer_store_dwordx4 v[160:163], v10, s[40:43], 0 offen offset:0
  buffer_store_dwordx4 v[164:167], v10, s[40:43], 0 offen offset:32
  buffer_store_dwordx4 v[168:171], v10, s[40:43], 0 offen offset:64
  buffer_store_dwordx4 v[172:175], v10, s[40:43], 0 offen offset:96
  s_endpgm
K2_LOADER:
  s_sub_u32 s52, s48, 4
  s_and_b32 s53, s52, 1
  s_lshr_b32 s54, s52, 1
  v_lshlrev_b32 v1, 4, v0
  v_lshrrev_b32 v2, 3, v0
  s_lshl_b32 s55, s52, 4
  v_add_u32 v2, s55, v2
  s_movk_i32 s55, 896
  v_mul_lo_u32 v2, s55, v2
  v_and_b32 v3, 7, v0
  v_lshrrev_b32 v4, 4, v0
  v_and_b32 v5, 1, v4
  v_lshlrev_b32 v5, 2, v5
  v_xor_b32 v5, v5, v3
  v_lshl_add_u32 v5, v5, 4, v2
  v_xor_b32 v6, v4, v3
  v_lshl_add_u32 v6, v6, 4, v2
  v_add_u32 v7, 4, v4
  v_xor_b32 v7, v7, v3
  v_lshl_add_u32 v7, v7, 4, v2
  v_add_u32 v7, 7168, v7
  s_lshl_b32 s58, s49, 1
  s_add_u32 s58, s58, s53
  s_lshl_b32 s59, s54, 1
  s_mul_i32 s56, s58, 112
  s_add_u32 s56, s56, s59
  s_lshl_b32 s56, s56, 10
  s_mul_i32 s57, s58, 56
  s_add_u32 s57, s57, s59
  s_lshl_b32 s57, s57, 10
  s_add_u32 s57, s57, 7340032
  s_lshl_b32 s60, s53, 2
  s_add_u32 s60, s60, s59
  s_lshl_b32 s60, s60, 10
  s_lshl_b32 s61, s52, 11
  s_lshl_b32 s62, s50, 7
  s_mul_i32 s63, s50, 57344
  s_mul_i32 s65, s71, 7
  s_lshl_b32 s68, s50, 2
  s_add_u32 s65, s65, s68
  s_cmp_ge_u32 s65, 28
  s_cselect_b32 s68, 28, 0
  s_sub_u32 s65, s65, s68
  s_lshl_b32 s66, s71, 1
  s_add_u32 s66, s66, s50
  s_cmp_ge_u32 s66, 7
  s_cselect_b32 s68, 7, 0
  s_sub_u32 s66, s66, s68
  s_mov_b32 s77, s65
  s_mov_b32 s78, s66
  s_add_u32 s77, s77, 1
  s_cmp_eq_u32 s77, 28
  s_cselect_b32 s77, 0, s77
  s_add_u32 s77, s77, 1
  s_cmp_eq_u32 s77, 28
  s_cselect_b32 s77, 0, s77
  s_add_u32 s77, s77, 1
  s_cmp_eq_u32 s77, 28
  s_cselect_b32 s77, 0, s77
  s_add_u32 s77, s77, 1
  s_cmp_eq_u32 s77, 28
  s_cselect_b32 s77, 0, s77
  s_add_u32 s77, s77, 1
  s_cmp_eq_u32 s77, 28
  s_cselect_b32 s77, 0, s77
  s_add_u32 s77, s77, 1
  s_cmp_eq_u32 s77, 28
  s_cselect_b32 s77, 0, s77
  s_add_u32 s77, s77, 1
  s_cmp_eq_u32 s77, 28
  s_cselect_b32 s77, 0, s77
  s_add_u32 s77, s77, 1
  s_cmp_eq_u32 s77, 28
  s_cselect_b32 s77, 0, s77
  s_add_u32 s77, s77, 1
  s_cmp_eq_u32 s77, 28
  s_cselect_b32 s77, 0, s77
  s_add_u32 s77, s77, 1
  s_cmp_eq_u32 s77, 28
  s_cselect_b32 s77, 0, s77
  s_add_u32 s77, s77, 1
  s_cmp_eq_u32 s77, 28
  s_cselect_b32 s77, 0, s77
  s_add_u32 s77, s77, 1
  s_cmp_eq_u32 s77, 28
  s_cselect_b32 s77, 0, s77
  v_and_b32 v8, 15, v0
  v_min_u32 v8, 13, v8
  v_lshlrev_b32 v8, 2, v8
  s_mov_b32 s80, 0
F_POLL_23:
  buffer_load_dword v9, v8, s[44:47], s76 offen offset:0 sc1
  s_waitcnt vmcnt(0)
  v_cmp_ne_u32 vcc, s98, v9
  s_nop 1
  s_cmp_eq_u64 vcc, 0
  s_cbranch_scc1 F_POLLOK_24
  s_add_u32 s80, s80, 1
  s_cmp_lt_u32 s80, 200000
  s_cbranch_scc1 F_POLL_23
F_POLLOK_24:
  s_lshl_b32 s69, s65, 12
  s_add_u32 s69, s69, s56
  s_add_u32 m0, s60, 122880
  s_nop 0
  buffer_load_dwordx4 v1, s[44:47], s69 offen lds
  s_add_u32 m0, s60, 123904
  s_add_u32 s69, s69, 1024
  buffer_load_dwordx4 v1, s[44:47], s69 offen lds
  s_add_u32 s65, s65, 1
  s_cmp_eq_u32 s65, 28
  s_cselect_b32 s65, 0, s65
  s_lshl_b32 s69, s65, 12
  s_add_u32 s69, s69, s56
  s_add_u32 m0, s60, 131072
  s_nop 0
  buffer_load_dwordx4 v1, s[44:47], s69 offen lds
  s_add_u32 m0, s60, 132096
  s_add_u32 s69, s69, 1024
  buffer_load_dwordx4 v1, s[44:47], s69 offen lds
  s_add_u32 s65, s65, 1
  s_cmp_eq_u32 s65, 28
  s_cselect_b32 s65, 0, s65
  s_waitcnt vmcnt(2)
  s_barrier
  s_lshl_b32 s69, s65, 12
  s_add_u32 s69, s69, s56
  s_add_u32 m0, s60, 139264
  s_nop 0
  buffer_load_dwordx4 v1, s[44:47], s69 offen lds
  s_add_u32 m0, s60, 140288
  s_add_u32 s69, s69, 1024
  buffer_load_dwordx4 v1, s[44:47], s69 offen lds
  s_add_u32 s65, s65, 1
  s_cmp_eq_u32 s65, 28
  s_cselect_b32 s65, 0, s65
  s_mul_i32 s70, s77, 57344
  s_add_u32 s70, s70, s62
  s_add_u32 m0, s61, 98304
  s_nop 0
  buffer_load_dwordx4 v5, s[36:39], s70 offen lds
  s_add_u32 m0, s61, 99328
  s_add_u32 s70, s70, 7168
  buffer_load_dwordx4 v5, s[36:39], s70 offen lds
  s_add_u32 s77, s77, 1
  s_cmp_eq_u32 s77, 28
  s_cselect_b32 s77, 0, s77
  s_lshl_b32 s69, s65, 12
  s_add_u32 s69, s69, s56
  s_add_u32 m0, s60, 147456
  s_nop 0
  buffer_load_dwordx4 v1, s[44:47], s69 offen lds
  s_add_u32 m0, s60, 148480
  s_add_u32 s69, s69, 1024
  buffer_load_dwordx4 v1, s[44:47], s69 offen lds
  s_add_u32 s65, s65, 1
  s_cmp_eq_u32 s65, 28
  s_cselect_b32 s65, 0, s65
  s_mul_i32 s70, s77, 57344
  s_add_u32 s70, s70, s62
  s_add_u32 m0, s61, 106496
  s_nop 0
  buffer_load_dwordx4 v5, s[36:39], s70 offen lds
  s_add_u32 m0, s61, 107520
  s_add_u32 s70, s70, 7168
  buffer_load_dwordx4 v5, s[36:39], s70 offen lds
  s_add_u32 s77, s77, 1
  s_cmp_eq_u32 s77, 28
  s_cselect_b32 s77, 0, s77
  s_waitcnt vmcnt(8)
  s_barrier
  s_lshl_b32 s69, s65, 12
  s_add_u32 s69, s69, s56
  s_add_u32 m0, s60, 155648
  s_nop 0
  buffer_load_dwordx4 v1, s[44:47], s69 offen lds
  s_add_u32 m0, s60, 156672
  s_add_u32 s69, s69, 1024
  buffer_load_dwordx4 v1, s[44:47], s69 offen lds
  s_add_u32 s65, s65, 1
  s_cmp_eq_u32 s65, 28
  s_cselect_b32 s65, 0, s65
  s_mul_i32 s70, s77, 57344
  s_add_u32 s70, s70, s62
  s_add_u32 m0, s61, 114688
  s_nop 0
  buffer_load_dwordx4 v5, s[36:39], s70 offen lds
  s_add_u32 m0, s61, 115712
  s_add_u32 s70, s70, 7168
  buffer_load_dwordx4 v5, s[36:39], s70 offen lds
  s_add_u32 s77, s77, 1
  s_cmp_eq_u32 s77, 28
  s_cselect_b32 s77, 0, s77
  s_waitcnt vmcnt(10)
  s_barrier
  s_lshl_b32 s69, s65, 12
  s_add_u32 s69, s69, s56
  s_add_u32 m0, s60, 122880
  s_nop 0
  buffer_load_dwordx4 v1, s[44:47], s69 offen lds
  s_add_u32 m0, s60, 123904
  s_add_u32 s69, s69, 1024
  buffer_load_dwordx4 v1, s[44:47], s69 offen lds
  s_add_u32 s65, s65, 1
  s_cmp_eq_u32 s65, 28
  s_cselect_b32 s65, 0, s65
  s_mul_i32 s70, s77, 57344
  s_add_u32 s70, s70, s62
  s_add_u32 m0, s61, 0
  s_nop 0
  buffer_load_dwordx4 v5, s[36:39], s70 offen lds
  s_add_u32 m0, s61, 1024
  s_add_u32 s70, s70, 7168
  buffer_load_dwordx4 v5, s[36:39], s70 offen lds
  s_add_u32 s77, s77, 1
  s_cmp_eq_u32 s77, 28
  s_cselect_b32 s77, 0, s77
  s_waitcnt vmcnt(10)
  s_barrier
  s_lshl_b32 s69, s65, 12
  s_add_u32 s69, s69, s56
  s_add_u32 m0, s60, 131072
  s_nop 0
  buffer_load_dwordx4 v1, s[44:47], s69 offen lds
  s_add_u32 m0, s60, 132096
  s_add_u32 s69, s69, 1024
  buffer_load_dwordx4 v1, s[44:47], s69 offen lds
  s_add_u32 s65, s65, 1
  s_cmp_eq_u32 s65, 28
  s_cselect_b32 s65, 0, s65
  s_mul_i32 s70, s77, 57344
  s_add_u32 s70, s70, s62
  s_add_u32 m0, s61, 8192
  s_nop 0
  buffer_load_dwordx4 v5, s[36:39], s70 offen lds
  s_add_u32 m0, s61, 9216
  s_add_u32 s70, s70, 7168
  buffer_load_dwordx4 v5, s[36:39], s70 offen lds
  s_add_u32 s77, s77, 1
  s_cmp_eq_u32 s77, 28
  s_cselect_b32 s77, 0, s77
  s_waitcnt vmcnt(10)
  s_barrier
  s_lshl_b32 s69, s65, 12
  s_add_u32 s69, s69, s56
  s_add_u32 m0, s60, 139264
  s_nop 0
  buffer_load_dwordx4 v1, s[44:47], s69 offen lds
  s_add_u32 m0, s60, 140288
  s_add_u32 s69, s69, 1024
  buffer_load_dwordx4 v1, s[44:47], s69 offen lds
  s_add_u32 s65, s65, 1
  s_cmp_eq_u32 s65, 28
  s_cselect_b32 s65, 0, s65
  s_mul_i32 s70, s77, 57344
  s_add_u32 s70, s70, s62
  s_add_u32 m0, s61, 16384
  s_nop 0
  buffer_load_dwordx4 v5, s[36:39], s70 offen lds
  s_add_u32 m0, s61, 17408
  s_add_u32 s70, s70, 7168
  buffer_load_dwordx4 v5, s[36:39], s70 offen lds
  s_add_u32 s77, s77, 1
  s_cmp_eq_u32 s77, 28
  s_cselect_b32 s77, 0, s77
  s_waitcnt vmcnt(10)
  s_barrier
  s_lshl_b32 s69, s65, 12
  s_add_u32 s69, s69, s56
  s_add_u32 m0, s60, 147456
  s_nop 0
  buffer_load_dwordx4 v1, s[44:47], s69 offen lds
  s_add_u32 m0, s60, 148480
  s_add_u32 s69, s69, 1024
  buffer_load_dwordx4 v1, s[44:47], s69 offen lds
  s_add_u32 s65, s65, 1
  s_cmp_eq_u32 s65, 28
  s_cselect_b32 s65, 0, s65
  s_mul_i32 s70, s77, 57344
  s_add_u32 s70, s70, s62
  s_add_u32 m0, s61, 24576
  s_nop 0
  buffer_load_dwordx4 v5, s[36:39], s70 offen lds
  s_add_u32 m0, s61, 25600
  s_add_u32 s70, s70, 7168
  buffer_load_dwordx4 v5, s[36:39], s70 offen lds
  s_add_u32 s77, s77, 1
  s_cmp_eq_u32 s77, 28
  s_cselect_b32 s77, 0, s77
  s_waitcnt vmcnt(10)
  s_barrier
  s_lshl_b32 s69, s65, 12
  s_add_u32 s69, s69, s56
  s_add_u32 m0, s60, 155648
  s_nop 0
  buffer_load_dwordx4 v1, s[44:47], s69 offen lds
  s_add_u32 m0, s60, 156672
  s_add_u32 s69, s69, 1024
  buffer_load_dwordx4 v1, s[44:47], s69 offen lds
  s_add_u32 s65, s65, 1
  s_cmp_eq_u32 s65, 28
  s_cselect_b32 s65, 0, s65
  s_mul_i32 s70, s77, 57344
  s_add_u32 s70, s70, s62
  s_add_u32 m0, s61, 32768
  s_nop 0
  buffer_load_dwordx4 v5, s[36:39], s70 offen lds
  s_add_u32 m0, s61, 33792
  s_add_u32 s70, s70, 7168
  buffer_load_dwordx4 v5, s[36:39], s70 offen lds
  s_add_u32 s77, s77, 1
  s_cmp_eq_u32 s77, 28
  s_cselect_b32 s77, 0, s77
  s_waitcnt vmcnt(10)
  s_barrier
  s_lshl_b32 s69, s65, 12
  s_add_u32 s69, s69, s56
  s_add_u32 m0, s60, 122880
  s_nop 0
  buffer_load_dwordx4 v1, s[44:47], s69 offen lds
  s_add_u32 m0, s60, 123904
  s_add_u32 s69, s69, 1024
  buffer_load_dwordx4 v1, s[44:47], s69 offen lds
  s_add_u32 s65, s65, 1
  s_cmp_eq_u32 s65, 28
  s_cselect_b32 s65, 0, s65
  s_mul_i32 s70, s77, 57344
  s_add_u32 s70, s70, s62
  s_add_u32 m0, s61, 40960
  s_nop 0
  buffer_load_dwordx4 v5, s[36:39], s70 offen lds
  s_add_u32 m0, s61, 41984
  s_add_u32 s70, s70, 7168
  buffer_load_dwordx4 v5, s[36:39], s70 offen lds
  s_add_u32 s77, s77, 1
  s_cmp_eq_u32 s77, 28
  s_cselect_b32 s77, 0, s77
  s_waitcnt vmcnt(10)
  s_barrier
  s_lshl_b32 s69, s65, 12
  s_add_u32 s69, s69, s56
  s_add_u32 m0, s60, 131072
  s_nop 0
  buffer_load_dwordx4 v1, s[44:47], s69 offen lds
  s_add_u32 m0, s60, 132096
  s_add_u32 s69, s69, 1024
  buffer_load_dwordx4 v1, s[44:47], s69 offen lds
  s_add_u32 s65, s65, 1
  s_cmp_eq_u32 s65, 28
  s_cselect_b32 s65, 0, s65
  s_mul_i32 s70, s77, 57344
  s_add_u32 s70, s70, s62
  s_add_u32 m0, s61, 49152
  s_nop 0
  buffer_load_dwordx4 v5, s[36:39], s70 offen lds
  s_add_u32 m0, s61, 50176
  s_add_u32 s70, s70, 7168
  buffer_load_dwordx4 v5, s[36:39], s70 offen lds
  s_add_u32 s77, s77, 1
  s_cmp_eq_u32 s77, 28
  s_cselect_b32 s77, 0, s77
  s_waitcnt vmcnt(10)
  s_barrier
  s_lshl_b32 s69, s65, 12
  s_add_u32 s69, s69, s56
  s_add_u32 m0, s60, 139264
  s_nop 0
  buffer_load_dwordx4 v1, s[44:47], s69 offen lds
  s_add_u32 m0, s60, 140288
  s_add_u32 s69, s69, 1024
  buffer_load_dwordx4 v1, s[44:47], s69 offen lds
  s_add_u32 s65, s65, 1
  s_cmp_eq_u32 s65, 28
  s_cselect_b32 s65, 0, s65
  s_mul_i32 s70, s77, 57344
  s_add_u32 s70, s70, s62
  s_add_u32 m0, s61, 57344
  s_nop 0
  buffer_load_dwordx4 v5, s[36:39], s70 offen lds
  s_add_u32 m0, s61, 58368
  s_add_u32 s70, s70, 7168
  buffer_load_dwordx4 v5, s[36:39], s70 offen lds
  s_add_u32 s77, s77, 1
  s_cmp_eq_u32 s77, 28
  s_cselect_b32 s77, 0, s77
  s_waitcnt vmcnt(10)
  s_barrier
  s_lshl_b32 s69, s65, 12
  s_add_u32 s69, s69, s56
  s_add_u32 m0, s60, 147456
  s_nop 0
  buffer_load_dwordx4 v1, s[44:47], s69 offen lds
  s_add_u32 m0, s60, 148480
  s_add_u32 s69, s69, 1024
  buffer_load_dwordx4 v1, s[44:47], s69 offen lds
  s_add_u32 s65, s65, 1
  s_cmp_eq_u32 s65, 28
  s_cselect_b32 s65, 0, s65
  s_mul_i32 s70, s77, 57344
  s_add_u32 s70, s70, s62
  s_add_u32 m0, s61, 65536
  s_nop 0
  buffer_load_dwordx4 v5, s[36:39], s70 offen lds
  s_add_u32 m0, s61, 66560
  s_add_u32 s70, s70, 7168
  buffer_load_dwordx4 v5, s[36:39], s70 offen lds
  s_add_u32 s77, s77, 1
  s_cmp_eq_u32 s77, 28
  s_cselect_b32 s77, 0, s77
  s_waitcnt vmcnt(10)
  s_barrier
  s_lshl_b32 s69, s65, 12
  s_add_u32 s69, s69, s56
  s_add_u32 m0, s60, 155648
  s_nop 0
  buffer_load_dwordx4 v1, s[44:47], s69 offen lds
  s_add_u32 m0, s60, 156672
  s_add_u32 s69, s69, 1024
  buffer_load_dwordx4 v1, s[44:47], s69 offen lds
  s_add_u32 s65, s65, 1
  s_cmp_eq_u32 s65, 28
  s_cselect_b32 s65, 0, s65
  s_mul_i32 s70, s77, 57344
  s_add_u32 s70, s70, s62
  s_add_u32 m0, s61, 73728
  s_nop 0
  buffer_load_dwordx4 v5, s[36:39], s70 offen lds
  s_add_u32 m0, s61, 74752
  s_add_u32 s70, s70, 7168
  buffer_load_dwordx4 v5, s[36:39], s70 offen lds
  s_add_u32 s77, s77, 1
  s_cmp_eq_u32 s77, 28
  s_cselect_b32 s77, 0, s77
  s_waitcnt vmcnt(10)
  s_barrier
  s_lshl_b32 s69, s65, 12
  s_add_u32 s69, s69, s56
  s_add_u32 m0, s60, 122880
  s_nop 0
  buffer_load_dwordx4 v1, s[44:47], s69 offen lds
  s_add_u32 m0, s60, 123904
  s_add_u32 s69, s69, 1024
  buffer_load_dwordx4 v1, s[44:47], s69 offen lds
  s_add_u32 s65, s65, 1
  s_cmp_eq_u32 s65, 28
  s_cselect_b32 s65, 0, s65
  s_mul_i32 s70, s77, 57344
  s_add_u32 s70, s70, s62
  s_add_u32 m0, s61, 81920
  s_nop 0
  buffer_load_dwordx4 v5, s[36:39], s70 offen lds
  s_add_u32 m0, s61, 82944
  s_add_u32 s70, s70, 7168
  buffer_load_dwordx4 v5, s[36:39], s70 offen lds
  s_add_u32 s77, s77, 1
  s_cmp_eq_u32 s77, 28
  s_cselect_b32 s77, 0, s77
  s_waitcnt vmcnt(10)
  s_barrier
  s_lshl_b32 s69, s65, 12
  s_add_u32 s69, s69, s56
  s_add_u32 m0, s60, 131072
  s_nop 0
  buffer_load_dwordx4 v1, s[44:47], s69 offen lds
  s_add_u32 m0, s60, 132096
  s_add_u32 s69, s69, 1024
  buffer_load_dwordx4 v1, s[44:47], s69 offen lds
  s_add_u32 s65, s65, 1
  s_cmp_eq_u32 s65, 28
  s_cselect_b32 s65, 0, s65
  s_mul_i32 s70, s77, 57344
  s_add_u32 s70, s70, s62
  s_add_u32 m0, s61, 90112
  s_nop 0
  buffer_load_dwordx4 v5, s[36:39], s70 offen lds
  s_add_u32 m0, s61, 91136
  s_add_u32 s70, s70, 7168
  buffer_load_dwordx4 v5, s[36:39], s70 offen lds
  s_add_u32 s77, s77, 1
  s_cmp_eq_u32 s77, 28
  s_cselect_b32 s77, 0, s77
  s_waitcnt vmcnt(10)
  s_barrier
  s_lshl_b32 s69, s65, 12
  s_add_u32 s69, s69, s56
  s_add_u32 m0, s60, 139264
  s_nop 0
  buffer_load_dwordx4 v1, s[44:47], s69 offen lds
  s_add_u32 m0, s60, 140288
  s_add_u32 s69, s69, 1024
  buffer_load_dwordx4 v1, s[44:47], s69 offen lds
  s_add_u32 s65, s65, 1
  s_cmp_eq_u32 s65, 28
  s_cselect_b32 s65, 0, s65
  s_mul_i32 s70, s77, 57344
  s_add_u32 s70, s70, s62
  s_add_u32 m0, s61, 98304
  s_nop 0
  buffer_load_dwordx4 v5, s[36:39], s70 offen lds
  s_add_u32 m0, s61, 99328
  s_add_u32 s70, s70, 7168
  buffer_load_dwordx4 v5, s[36:39], s70 offen lds
  s_add_u32 s77, s77, 1
  s_cmp_eq_u32 s77, 28
  s_cselect_b32 s77, 0, s77
  s_waitcnt vmcnt(10)
  s_barrier
  s_lshl_b32 s69, s65, 12
  s_add_u32 s69, s69, s56
  s_add_u32 m0, s60, 147456
  s_nop 0
  buffer_load_dwordx4 v1, s[44:47], s69 offen lds
  s_add_u32 m0, s60, 148480
  s_add_u32 s69, s69, 1024
  buffer_load_dwordx4 v1, s[44:47], s69 offen lds
  s_add_u32 s65, s65, 1
  s_cmp_eq_u32 s65, 28
  s_cselect_b32 s65, 0, s65
  s_lshl_b32 s70, s78, 7
  s_add_u32 s70, s70, s63
  s_add_u32 m0, s61, 106496
  s_nop 0
  buffer_load_dwordx4 v6, s[24:27], s70 offen lds
  s_add_u32 m0, s61, 107520
  s_nop 0
  buffer_load_dwordx4 v7, s[24:27], s70 offen lds
  s_waitcnt vmcnt(10)
  s_barrier
  s_lshl_b32 s69, s65, 12
  s_add_u32 s69, s69, s56
  s_add_u32 m0, s60, 155648
  s_nop 0
  buffer_load_dwordx4 v1, s[44:47], s69 offen lds
  s_add_u32 m0, s60, 156672
  s_add_u32 s69, s69, 1024
  buffer_load_dwordx4 v1, s[44:47], s69 offen lds
  s_add_u32 s65, s65, 1
  s_cmp_eq_u32 s65, 28
  s_cselect_b32 s65, 0, s65
  s_lshl_b32 s70, s78, 7
  s_add_u32 s70, s70, s63
  s_add_u32 m0, s61, 114688
  s_nop 0
  buffer_load_dwordx4 v6, s[28:31], s70 offen lds
  s_add_u32 m0, s61, 115712
  s_nop 0
  buffer_load_dwordx4 v7, s[28:31], s70 offen lds
  s_add_u32 s78, s78, 1
  s_cmp_eq_u32 s78, 7
  s_cselect_b32 s78, 0, s78
  s_waitcnt vmcnt(10)
  s_barrier
  s_lshl_b32 s69, s65, 12
  s_add_u32 s69, s69, s56
  s_add_u32 m0, s60, 122880
  s_nop 0
  buffer_load_dwordx4 v1, s[44:47], s69 offen lds
  s_add_u32 m0, s60, 123904
  s_add_u32 s69, s69, 1024
  buffer_load_dwordx4 v1, s[44:47], s69 offen lds
  s_add_u32 s65, s65, 1
  s_cmp_eq_u32 s65, 28
  s_cselect_b32 s65, 0, s65
  s_lshl_b32 s70, s78, 7
  s_add_u32 s70, s70, s63
  s_add_u32 m0, s61, 0
  s_nop 0
  buffer_load_dwordx4 v6, s[24:27], s70 offen lds
  s_add_u32 m0, s61, 1024
  s_nop 0
  buffer_load_dwordx4 v7, s[24:27], s70 offen lds
  s_waitcnt vmcnt(10)
  s_barrier
  s_lshl_b32 s69, s65, 12
  s_add_u32 s69, s69, s56
  s_add_u32 m0, s60, 131072
  s_nop 0
  buffer_load_dwordx4 v1, s[44:47], s69 offen lds
  s_add_u32 m0, s60, 132096
  s_add_u32 s69, s69, 1024
  buffer_load_dwordx4 v1, s[44:47], s69 offen lds
  s_add_u32 s65, s65, 1
  s_cmp_eq_u32 s65, 28
  s_cselect_b32 s65, 0, s65
  s_lshl_b32 s70, s78, 7
  s_add_u32 s70, s70, s63
  s_add_u32 m0, s61, 8192
  s_nop 0
  buffer_load_dwordx4 v6, s[28:31], s70 offen lds
  s_add_u32 m0, s61, 9216
  s_nop 0
  buffer_load_dwordx4 v7, s[28:31], s70 offen lds
  s_add_u32 s78, s78, 1
  s_cmp_eq_u32 s78, 7
  s_cselect_b32 s78, 0, s78
  s_waitcnt vmcnt(10)
  s_barrier
  s_lshl_b32 s69, s65, 12
  s_add_u32 s69, s69, s56
  s_add_u32 m0, s60, 139264
  s_nop 0
  buffer_load_dwordx4 v1, s[44:47], s69 offen lds
  s_add_u32 m0, s60, 140288
  s_add_u32 s69, s69, 1024
  buffer_load_dwordx4 v1, s[44:47], s69 offen lds
  s_add_u32 s65, s65, 1
  s_cmp_eq_u32 s65, 28
  s_cselect_b32 s65, 0, s65
  s_lshl_b32 s70, s78, 7
  s_add_u32 s70, s70, s63
  s_add_u32 m0, s61, 16384
  s_nop 0
  buffer_load_dwordx4 v6, s[24:27], s70 offen lds
  s_add_u32 m0, s61, 17408
  s_nop 0
  buffer_load_dwordx4 v7, s[24:27], s70 offen lds
  s_waitcnt vmcnt(10)
  s_barrier
  s_lshl_b32 s69, s65, 12
  s_add_u32 s69, s69, s56
  s_add_u32 m0, s60, 147456
  s_nop 0
  buffer_load_dwordx4 v1, s[44:47], s69 offen lds
  s_add_u32 m0, s60, 148480
  s_add_u32 s69, s69, 1024
  buffer_load_dwordx4 v1, s[44:47], s69 offen lds
  s_add_u32 s65, s65, 1
  s_cmp_eq_u32 s65, 28
  s_cselect_b32 s65, 0, s65
  s_lshl_b32 s70, s78, 7
  s_add_u32 s70, s70, s63
  s_add_u32 m0, s61, 24576
  s_nop 0
  buffer_load_dwordx4 v6, s[28:31], s70 offen lds
  s_add_u32 m0, s61, 25600
  s_nop 0
  buffer_load_dwordx4 v7, s[28:31], s70 offen lds
  s_add_u32 s78, s78, 1
  s_cmp_eq_u32 s78, 7
  s_cselect_b32 s78, 0, s78
  s_waitcnt vmcnt(10)
  s_barrier
  buffer_load_dword v9, v8, s[44:47], s76 offen offset:64 sc1
  s_lshl_b32 s69, s65, 12
  s_add_u32 s69, s69, s56
  s_add_u32 m0, s60, 155648
  s_nop 0
  buffer_load_dwordx4 v1, s[44:47], s69 offen lds
  s_add_u32 m0, s60, 156672
  s_add_u32 s69, s69, 1024
  buffer_load_dwordx4 v1, s[44:47], s69 offen lds
  s_add_u32 s65, s65, 1
  s_cmp_eq_u32 s65, 28
  s_cselect_b32 s65, 0, s65
  s_lshl_b32 s70, s78, 7
  s_add_u32 s70, s70, s63
  s_add_u32 m0, s61, 32768
  s_nop 0
  buffer_load_dwordx4 v6, s[24:27], s70 offen lds
  s_add_u32 m0, s61, 33792
  s_nop 0
  buffer_load_dwordx4 v7, s[24:27], s70 offen lds
  s_waitcnt vmcnt(11)
  s_barrier
  s_lshl_b32 s69, s65, 12
  s_add_u32 s69, s69, s56
  s_add_u32 m0, s60, 122880
  s_nop 0
  buffer_load_dwordx4 v1, s[44:47], s69 offen lds
  s_add_u32 m0, s60, 123904
  s_add_u32 s69, s69, 1024
  buffer_load_dwordx4 v1, s[44:47], s69 offen lds
  s_add_u32 s65, s65, 1
  s_cmp_eq_u32 s65, 28
  s_cselect_b32 s65, 0, s65
  s_lshl_b32 s70, s78, 7
  s_add_u32 s70, s70, s63
  s_add_u32 m0, s61, 40960
  s_nop 0
  buffer_load_dwordx4 v6, s[28:31], s70 offen lds
  s_add_u32 m0, s61, 41984
  s_nop 0
  buffer_load_dwordx4 v7, s[28:31], s70 offen lds
  s_add_u32 s78, s78, 1
  s_cmp_eq_u32 s78, 7
  s_cselect_b32 s78, 0, s78
  s_waitcnt vmcnt(11)
  s_barrier
  s_lshl_b32 s69, s65, 12
  s_add_u32 s69, s69, s56
  s_add_u32 m0, s60, 131072
  s_nop 0
  buffer_load_dwordx4 v1, s[44:47], s69 offen lds
  s_add_u32 m0, s60, 132096
  s_add_u32 s69, s69, 1024
  buffer_load_dwordx4 v1, s[44:47], s69 offen lds
  s_add_u32 s65, s65, 1
  s_cmp_eq_u32 s65, 28
  s_cselect_b32 s65, 0, s65
  s_lshl_b32 s70, s78, 7
  s_add_u32 s70, s70, s63
  s_add_u32 m0, s61, 49152
  s_nop 0
  buffer_load_dwordx4 v6, s[24:27], s70 offen lds
  s_add_u32 m0, s61, 50176
  s_nop 0
  buffer_load_dwordx4 v7, s[24:27], s70 offen lds
  s_waitcnt vmcnt(10)
  s_barrier
  s_lshl_b32 s69, s65, 12
  s_add_u32 s69, s69, s56
  s_add_u32 m0, s60, 139264
  s_nop 0
  buffer_load_dwordx4 v1, s[44:47], s69 offen lds
  s_add_u32 m0, s60, 140288
  s_add_u32 s69, s69, 1024
  buffer_load_dwordx4 v1, s[44:47], s69 offen lds
  s_add_u32 s65, s65, 1
  s_cmp_eq_u32 s65, 28
  s_cselect_b32 s65, 0, s65
  s_lshl_b32 s70, s78, 7
  s_add_u32 s70, s70, s63
  s_add_u32 m0, s61, 57344
  s_nop 0
  buffer_load_dwordx4 v6, s[28:31], s70 offen lds
  s_add_u32 m0, s61, 58368
  s_nop 0
  buffer_load_dwordx4 v7, s[28:31], s70 offen lds
  s_add_u32 s78, s78, 1
  s_cmp_eq_u32 s78, 7
  s_cselect_b32 s78, 0, s78
  s_waitcnt vmcnt(10)
  s_barrier
  v_cmp_ne_u32 vcc, s98, v9
  s_nop 1
  s_cmp_eq_u64 vcc, 0
  s_cbranch_scc1 F_PCOK_25
  v_and_b32 v8, 15, v0
  v_min_u32 v8, 13, v8
  v_lshlrev_b32 v8, 2, v8
  s_mov_b32 s80, 0
F_POLL_26:
  buffer_load_dword v9, v8, s[44:47], s76 offen offset:64 sc1
  s_waitcnt vmcnt(0)
  v_cmp_ne_u32 vcc, s98, v9
  s_nop 1
  s_cmp_eq_u64 vcc, 0
  s_cbranch_scc1 F_POLLOK_27
  s_add_u32 s80, s80, 1
  s_cmp_lt_u32 s80, 200000
  s_cbranch_scc1 F_POLL_26
F_POLLOK_27:
F_PCOK_25:
  s_lshl_b32 s69, s66, 13
  s_add_u32 s69, s69, s57
  s_add_u32 m0, s60, 147456
  s_nop 0
  buffer_load_dwordx4 v1, s[44:47], s69 offen lds
  s_add_u32 m0, s60, 148480
  s_add_u32 s69, s69, 1024
  buffer_load_dwordx4 v1, s[44:47], s69 offen lds
  s_lshl_b32 s70, s78, 7
  s_add_u32 s70, s70, s63
  s_add_u32 m0, s61, 65536
  s_nop 0
  buffer_load_dwordx4 v6, s[24:27], s70 offen lds
  s_add_u32 m0, s61, 66560
  s_nop 0
  buffer_load_dwordx4 v7, s[24:27], s70 offen lds
  s_waitcnt vmcnt(10)
  s_barrier
  s_lshl_b32 s69, s66, 13
  s_add_u32 s69, s69, s57
  s_add_u32 s69, s69, 4096
  s_add_u32 m0, s60, 155648
  s_nop 0
  buffer_load_dwordx4 v1, s[44:47], s69 offen lds
  s_add_u32 m0, s60, 156672
  s_add_u32 s69, s69, 1024
  buffer_load_dwordx4 v1, s[44:47], s69 offen lds
  s_add_u32 s66, s66, 1
  s_cmp_eq_u32 s66, 7
  s_cselect_b32 s66, 0, s66
  s_lshl_b32 s70, s78, 7
  s_add_u32 s70, s70, s63
  s_add_u32 m0, s61, 73728
  s_nop 0
  buffer_load_dwordx4 v6, s[28:31], s70 offen lds
  s_add_u32 m0, s61, 74752
  s_nop 0
  buffer_load_dwordx4 v7, s[28:31], s70 offen lds
  s_add_u32 s78, s78, 1
  s_cmp_eq_u32 s78, 7
  s_cselect_b32 s78, 0, s78
  s_waitcnt vmcnt(10)
  s_barrier
  s_lshl_b32 s69, s66, 13
  s_add_u32 s69, s69, s57
  s_add_u32 m0, s60, 122880
  s_nop 0
  buffer_load_dwordx4 v1, s[44:47], s69 offen lds
  s_add_u32 m0, s60, 123904
  s_add_u32 s69, s69, 1024
  buffer_load_dwordx4 v1, s[44:47], s69 offen lds
  s_lshl_b32 s70, s78, 7
  s_add_u32 s70, s70, s63
  s_add_u32 m0, s61, 81920
  s_nop 0
  buffer_load_dwordx4 v6, s[24:27], s70 offen lds
  s_add_u32 m0, s61, 82944
  s_nop 0
  buffer_load_dwordx4 v7, s[24:27], s70 offen lds
  s_waitcnt vmcnt(10)
  s_barrier
  s_lshl_b32 s69, s66, 13
  s_add_u32 s69, s69, s57
  s_add_u32 s69, s69, 4096
  s_add_u32 m0, s60, 131072
  s_nop 0
  buffer_load_dwordx4 v1, s[44:47], s69 offen lds
  s_add_u32 m0, s60, 132096
  s_add_u32 s69, s69, 1024
  buffer_load_dwordx4 v1, s[44:47], s69 offen lds
  s_add_u32 s66, s66, 1
  s_cmp_eq_u32 s66, 7
  s_cselect_b32 s66, 0, s66
  s_lshl_b32 s70, s78, 7
  s_add_u32 s70, s70, s63
  s_add_u32 m0, s61, 90112
  s_nop 0
  buffer_load_dwordx4 v6, s[28:31], s70 offen lds
  s_add_u32 m0, s61, 91136
  s_nop 0
  buffer_load_dwordx4 v7, s[28:31], s70 offen lds
  s_add_u32 s78, s78, 1
  s_cmp_eq_u32 s78, 7
  s_cselect_b32 s78, 0, s78
  s_waitcnt vmcnt(10)
  s_barrier
  s_lshl_b32 s69, s66, 13
  s_add_u32 s69, s69, s57
  s_add_u32 m0, s60, 139264
  s_nop 0
  buffer_load_dwordx4 v1, s[44:47], s69 offen lds
  s_add_u32 m0, s60, 140288
  s_add_u32 s69, s69, 1024
  buffer_load_dwordx4 v1, s[44:47], s69 offen lds
  s_waitcnt vmcnt(8)
  s_barrier
  s_lshl_b32 s69, s66, 13
  s_add_u32 s69, s69, s57
  s_add_u32 s69, s69, 4096
  s_add_u32 m0, s60, 147456
  s_nop 0
  buffer_load_dwordx4 v1, s[44:47], s69 offen lds
  s_add_u32 m0, s60, 148480
  s_add_u32 s69, s69, 1024
  buffer_load_dwordx4 v1, s[44:47], s69 offen lds
  s_add_u32 s66, s66, 1
  s_cmp_eq_u32 s66, 7
  s_cselect_b32 s66, 0, s66
  s_waitcnt vmcnt(6)
  s_barrier
  s_lshl_b32 s69, s66, 13
  s_add_u32 s69, s69, s57
  s_add_u32 m0, s60, 155648
  s_nop 0
  buffer_load_dwordx4 v1, s[44:47], s69 offen lds
  s_add_u32 m0, s60, 156672
  s_add_u32 s69, s69, 1024
  buffer_load_dwordx4 v1, s[44:47], s69 offen lds
  s_waitcnt vmcnt(4)
  s_barrier
  s_lshl_b32 s69, s66, 13
  s_add_u32 s69, s69, s57
  s_add_u32 s69, s69, 4096
  s_add_u32 m0, s60, 122880
  s_nop 0
  buffer_load_dwordx4 v1, s[44:47], s69 offen lds
  s_add_u32 m0, s60, 123904
  s_add_u32 s69, s69, 1024
  buffer_load_dwordx4 v1, s[44:47], s69 offen lds
  s_add_u32 s66, s66, 1
  s_cmp_eq_u32 s66, 7
  s_cselect_b32 s66, 0, s66
  s_waitcnt vmcnt(4)
  s_barrier
  s_lshl_b32 s69, s66, 13
  s_add_u32 s69, s69, s57
  s_add_u32 m0, s60, 131072
  s_nop 0
  buffer_load_dwordx4 v1, s[44:47], s69 offen lds
  s_add_u32 m0, s60, 132096
  s_add_u32 s69, s69, 1024
  buffer_load_dwordx4 v1, s[44:47], s69 offen lds
  s_waitcnt vmcnt(4)
  s_barrier
  s_lshl_b32 s69, s66, 13
  s_add_u32 s69, s69, s57
  s_add_u32 s69, s69, 4096
  s_add_u32 m0, s60, 139264
  s_nop 0
  buffer_load_dwordx4 v1, s[44:47], s69 offen lds
  s_add_u32 m0, s60, 140288
  s_add_u32 s69, s69, 1024
  buffer_load_dwordx4 v1, s[44:47], s69 offen lds
  s_add_u32 s66, s66, 1
  s_cmp_eq_u32 s66, 7
  s_cselect_b32 s66, 0, s66
  s_waitcnt vmcnt(4)
  s_barrier
  s_lshl_b32 s69, s66, 13
  s_add_u32 s69, s69, s57
  s_add_u32 m0, s60, 147456
  s_nop 0
  buffer_load_dwordx4 v1, s[44:47], s69 offen lds
  s_add_u32 m0, s60, 148480
  s_add_u32 s69, s69, 1024
  buffer_load_dwordx4 v1, s[44:47], s69 offen lds
  s_waitcnt vmcnt(4)
  s_barrier
  s_lshl_b32 s69, s66, 13
  s_add_u32 s69, s69, s57
  s_add_u32 s69, s69, 4096
  s_add_u32 m0, s60, 155648
  s_nop 0
  buffer_load_dwordx4 v1, s[44:47], s69 offen lds
  s_add_u32 m0, s60, 156672
  s_add_u32 s69, s69, 1024
  buffer_load_dwordx4 v1, s[44:47], s69 offen lds
  s_add_u32 s66, s66, 1
  s_cmp_eq_u32 s66, 7
  s_cselect_b32 s66, 0, s66
  s_waitcnt vmcnt(4)
  s_barrier
  s_lshl_b32 s69, s66, 13
  s_add_u32 s69, s69, s57
  s_add_u32 m0, s60, 122880
  s_nop 0
  buffer_load_dwordx4 v1, s[44:47], s69 offen lds
  s_add_u32 m0, s60, 123904
  s_add_u32 s69, s69, 1024
  buffer_load_dwordx4 v1, s[44:47], s69 offen lds
  s_waitcnt vmcnt(4)
  s_barrier
  s_lshl_b32 s69, s66, 13
  s_add_u32 s69, s69, s57
  s_add_u32 s69, s69, 4096
  s_add_u32 m0, s60, 131072
  s_nop 0
  buffer_load_dwordx4 v1, s[44:47], s69 offen lds
  s_add_u32 m0, s60, 132096
  s_add_u32 s69, s69, 1024
  buffer_load_dwordx4 v1, s[44:47], s69 offen lds
  s_add_u32 s66, s66, 1
  s_cmp_eq_u32 s66, 7
  s_cselect_b32 s66, 0, s66
  s_waitcnt vmcnt(4)
  s_barrier
  s_waitcnt vmcnt(2)
  s_barrier
  s_waitcnt vmcnt(0)
  s_barrier
K2_END:
  s_endpgm
K1_END:
  s_endpgm
K1_HELPER:
  s_lshr_b32 s52, s2, 3
  s_lshl_b32 s52, s52, 2
  s_and_b32 s53, s2, 3
  s_add_u32 s52, s52, s53
  s_cmp_ge_u32 s52, 14
  s_cbranch_scc1 K1H_WARM
  s_bfe_u32 s53, s2, 0x10002
  s_mul_i32 s53, s53, 7
  s_mov_b32 s32, s18
  s_and_b32 s33, s19, 0xffff
  s_mov_b32 s34, 11195392
  s_mov_b32 s35, 0x20000
  s_mov_b32 s36, s16
  s_and_b32 s37, s17, 0xffff
  s_mov_b32 s38, 256
  s_mov_b32 s39, 0x20000
  s_cmp_ge_u32 s52, 7
  s_cselect_b32 s28, s14, s12
  s_cselect_b32 s29, s15, s13
  s_cselect_b32 s54, 7, 0
  s_cselect_b32 s56, 1792, 0
  s_and_b32 s29, s29, 0xffff
  s_sub_u32 s54, s52, s54
  s_add_u32 s54, s54, s53
  s_mov_b32 s30, 1605632
  s_mov_b32 s31, 0x20000
  v_lshrrev_b32 v4, 4, v0
  s_movk_i32 s50, 3584
  v_mul_lo_u32 v4, s50, v4
  v_and_b32 v5, 15, v0
  v_lshl_add_u32 v4, v5, 4, v4
  s_mul_i32 s55, s48, 200704
  s_lshl_b32 s57, s54, 8
  s_add_u32 s55, s55, s57
  v_mov_b32 v14, 0
  s_cmp_lg_u32 s48, 0
  s_cbranch_scc1 K1_NC_28
  s_memrealtime s[100:101]
  s_waitcnt lgkmcnt(0)
  s_or_b32 s99, s100, 1
  v_mov_b32 v12, s99
  v_mov_b32 v13, 0
  s_mov_b64 s[58:59], exec
  s_mov_b64 exec, 1
  buffer_atomic_cmpswap v[12:13], v14, s[36:39], 0 offen sc0
  s_mov_b64 exec, s[58:59]
K1_NC_28:
  s_add_u32 s57, s55, 0
  buffer_load_dwordx4 v[72:75], v4, s[28:31], s57 offen
  s_add_u32 s57, s55, 14336
  buffer_load_dwordx4 v[76:79], v4, s[28:31], s57 offen
  s_add_u32 s57, s55, 28672
  buffer_load_dwordx4 v[80:83], v4, s[28:31], s57 offen
  s_add_u32 s57, s55, 43008
  buffer_load_dwordx4 v[84:87], v4, s[28:31], s57 offen
  s_add_u32 s57, s55, 57344
  buffer_load_dwordx4 v[88:91], v4, s[28:31], s57 offen
  s_add_u32 s57, s55, 71680
  buffer_load_dwordx4 v[92:95], v4, s[28:31], s57 offen
  s_add_u32 s57, s55, 86016
  buffer_load_dwordx4 v[96:99], v4, s[28:31], s57 offen
  s_add_u32 s57, s55, 100352
  buffer_load_dwordx4 v[100:103], v4, s[28:31], s57 offen
  s_add_u32 s57, s55, 114688
  buffer_load_dwordx4 v[104:107], v4, s[28:31], s57 offen
  s_add_u32 s57, s55, 129024
  buffer_load_dwordx4 v[108:111], v4, s[28:31], s57 offen
  s_add_u32 s57, s55, 143360
  buffer_load_dwordx4 v[112:115], v4, s[28:31], s57 offen
  s_add_u32 s57, s55, 157696
  buffer_load_dwordx4 v[116:119], v4, s[28:31], s57 offen
  s_add_u32 s57, s55, 172032
  buffer_load_dwordx4 v[120:123], v4, s[28:31], s57 offen
  s_add_u32 s57, s55, 186368
  buffer_load_dwordx4 v[124:127], v4, s[28:31], s57 offen
  s_waitcnt vmcnt(13)
  s_cmp_lg_u32 s48, 0
  s_cbranch_scc1 K1_NP_29
  s_waitcnt vmcnt(14)
  v_readfirstlane_b32 s100, v12
  s_nop 1
  s_cmp_eq_u32 s100, 0
  s_cselect_b32 s100, s99, s100
  v_mov_b32 v12, s100
  v_mov_b32 v13, 32768
  ds_write_b32 v13, v12
  s_waitcnt lgkmcnt(0)
K1_NP_29:
  v_lshlrev_b32 v16, 16, v72
  v_and_b32 v17, 0xffff0000, v72
  v_lshlrev_b32 v18, 16, v73
  v_and_b32 v19, 0xffff0000, v73
  v_lshlrev_b32 v20, 16, v74
  v_and_b32 v21, 0xffff0000, v74
  v_lshlrev_b32 v22, 16, v75
  v_and_b32 v23, 0xffff0000, v75
  s_waitcnt vmcnt(12)
  v_lshlrev_b32 v6, 16, v76
  v_and_b32 v7, 0xffff0000, v76
  v_add_f32 v16, v16, v6
  v_add_f32 v17, v17, v7
  v_lshlrev_b32 v6, 16, v77
  v_and_b32 v7, 0xffff0000, v77
  v_add_f32 v18, v18, v6
  v_add_f32 v19, v19, v7
  v_lshlrev_b32 v6, 16, v78
  v_and_b32 v7, 0xffff0000, v78
  v_add_f32 v20, v20, v6
  v_add_f32 v21, v21, v7
  v_lshlrev_b32 v6, 16, v79
  v_and_b32 v7, 0xffff0000, v79
  v_add_f32 v22, v22, v6
  v_add_f32 v23, v23, v7
  s_waitcnt vmcnt(11)
  v_lshlrev_b32 v6, 16, v80
  v_and_b32 v7, 0xffff0000, v80
  v_add_f32 v16, v16, v6
  v_add_f32 v17, v17, v7
  v_lshlrev_b32 v6, 16, v81
  v_and_b32 v7, 0xffff0000, v81
  v_add_f32 v18, v18, v6
  v_add_f32 v19, v19, v7
  v_lshlrev_b32 v6, 16, v82
  v_and_b32 v7, 0xffff0000, v82
  v_add_f32 v20, v20, v6
  v_add_f32 v21, v21, v7
  v_lshlrev_b32 v6, 16, v83
  v_and_b32 v7, 0xffff0000, v83
  v_add_f32 v22, v22, v6
  v_add_f32 v23, v23, v7
  s_waitcnt vmcnt(10)
  v_lshlrev_b32 v6, 16, v84
  v_and_b32 v7, 0xffff0000, v84
  v_add_f32 v16, v16, v6
  v_add_f32 v17, v17, v7
  v_lshlrev_b32 v6, 16, v85
  v_and_b32 v7, 0xffff0000, v85
  v_add_f32 v18, v18, v6
  v_add_f32 v19, v19, v7
  v_lshlrev_b32 v6, 16, v86
  v_and_b32 v7, 0xffff0000, v86
  v_add_f32 v20, v20, v6
  v_add_f32 v21, v21, v7
  v_lshlrev_b32 v6, 16, v87
  v_and_b32 v7, 0xffff0000, v87
  v_add_f32 v22, v22, v6
  v_add_f32 v23, v23, v7
  s_waitcnt vmcnt(9)
  v_lshlrev_b32 v6, 16, v88
  v_and_b32 v7, 0xffff0000, v88
  v_add_f32 v16, v16, v6
  v_add_f32 v17, v17, v7
  v_lshlrev_b32 v6, 16, v89
  v_and_b32 v7, 0xffff0000, v89
  v_add_f32 v18, v18, v6
  v_add_f32 v19, v19, v7
  v_lshlrev_b32 v6, 16, v90
  v_and_b32 v7, 0xffff0000, v90
  v_add_f32 v20, v20, v6
  v_add_f32 v21, v21, v7
  v_lshlrev_b32 v6, 16, v91
  v_and_b32 v7, 0xffff0000, v91
  v_add_f32 v22, v22, v6
  v_add_f32 v23, v23, v7
  s_waitcnt vmcnt(8)
  v_lshlrev_b32 v6, 16, v92
  v_and_b32 v7, 0xffff0000, v92
  v_add_f32 v16, v16, v6
  v_add_f32 v17, v17, v7
  v_lshlrev_b32 v6, 16, v93
  v_and_b32 v7, 0xffff0000, v93
  v_add_f32 v18, v18, v6
  v_add_f32 v19, v19, v7
  v_lshlrev_b32 v6, 16, v94
  v_and_b32 v7, 0xffff0000, v94
  v_add_f32 v20, v20, v6
  v_add_f32 v21, v21, v7
  v_lshlrev_b32 v6, 16, v95
  v_and_b32 v7, 0xffff0000, v95
  v_add_f32 v22, v22, v6
  v_add_f32 v23, v23, v7
  s_waitcnt vmcnt(7)
  v_lshlrev_b32 v6, 16, v96
  v_and_b32 v7, 0xffff0000, v96
  v_add_f32 v16, v16, v6
  v_add_f32 v17, v17, v7
  v_lshlrev_b32 v6, 16, v97
  v_and_b32 v7, 0xffff0000, v97
  v_add_f32 v18, v18, v6
  v_add_f32 v19, v19, v7
  v_lshlrev_b32 v6, 16, v98
  v_and_b32 v7, 0xffff0000, v98
  v_add_f32 v20, v20, v6
  v_add_f32 v21, v21, v7
  v_lshlrev_b32 v6, 16, v99
  v_and_b32 v7, 0xffff0000, v99
  v_add_f32 v22, v22, v6
  v_add_f32 v23, v23, v7
  s_waitcnt vmcnt(6)
  v_lshlrev_b32 v6, 16, v100
  v_and_b32 v7, 0xffff0000, v100
  v_add_f32 v16, v16, v6
  v_add_f32 v17, v17, v7
  v_lshlrev_b32 v6, 16, v101
  v_and_b32 v7, 0xffff0000, v101
  v_add_f32 v18, v18, v6
  v_add_f32 v19, v19, v7
  v_lshlrev_b32 v6, 16, v102
  v_and_b32 v7, 0xffff0000, v102
  v_add_f32 v20, v20, v6
  v_add_f32 v21, v21, v7
  v_lshlrev_b32 v6, 16, v103
  v_and_b32 v7, 0xffff0000, v103
  v_add_f32 v22, v22, v6
  v_add_f32 v23, v23, v7
  s_waitcnt vmcnt(5)
  v_lshlrev_b32 v6, 16, v104
  v_and_b32 v7, 0xffff0000, v104
  v_add_f32 v16, v16, v6
  v_add_f32 v17, v17, v7
  v_lshlrev_b32 v6, 16, v105
  v_and_b32 v7, 0xffff0000, v105
  v_add_f32 v18, v18, v6
  v_add_f32 v19, v19, v7
  v_lshlrev_b32 v6, 16, v106
  v_and_b32 v7, 0xffff0000, v106
  v_add_f32 v20, v20, v6
  v_add_f32 v21, v21, v7
  v_lshlrev_b32 v6, 16, v107
  v_and_b32 v7, 0xffff0000, v107
  v_add_f32 v22, v22, v6
  v_add_f32 v23, v23, v7
  s_waitcnt vmcnt(4)
  v_lshlrev_b32 v6, 16, v108
  v_and_b32 v7, 0xffff0000, v108
  v_add_f32 v16, v16, v6
  v_add_f32 v17, v17, v7
  v_lshlrev_b32 v6, 16, v109
  v_and_b32 v7, 0xffff0000, v109
  v_add_f32 v18, v18, v6
  v_add_f32 v19, v19, v7
  v_lshlrev_b32 v6, 16, v110
  v_and_b32 v7, 0xffff0000, v110
  v_add_f32 v20, v20, v6
  v_add_f32 v21, v21, v7
  v_lshlrev_b32 v6, 16, v111
  v_and_b32 v7, 0xffff0000, v111
  v_add_f32 v22, v22, v6
  v_add_f32 v23, v23, v7
  s_waitcnt vmcnt(3)
  v_lshlrev_b32 v6, 16, v112
  v_and_b32 v7, 0xffff0000, v112
  v_add_f32 v16, v16, v6
  v_add_f32 v17, v17, v7
  v_lshlrev_b32 v6, 16, v113
  v_and_b32 v7, 0xffff0000, v113
  v_add_f32 v18, v18, v6
  v_add_f32 v19, v19, v7
  v_lshlrev_b32 v6, 16, v114
  v_and_b32 v7, 0xffff0000, v114
  v_add_f32 v20, v20, v6
  v_add_f32 v21, v21, v7
  v_lshlrev_b32 v6, 16, v115
  v_and_b32 v7, 0xffff0000, v115
  v_add_f32 v22, v22, v6
  v_add_f32 v23, v23, v7
  s_waitcnt vmcnt(2)
  v_lshlrev_b32 v6, 16, v116
  v_and_b32 v7, 0xffff0000, v116
  v_add_f32 v16, v16, v6
  v_add_f32 v17, v17, v7
  v_lshlrev_b32 v6, 16, v117
  v_and_b32 v7, 0xffff0000, v117
  v_add_f32 v18, v18, v6
  v_add_f32 v19, v19, v7
  v_lshlrev_b32 v6, 16, v118
  v_and_b32 v7, 0xffff0000, v118
  v_add_f32 v20, v20, v6
  v_add_f32 v21, v21, v7
  v_lshlrev_b32 v6, 16, v119
  v_and_b32 v7, 0xffff0000, v119
  v_add_f32 v22, v22, v6
  v_add_f32 v23, v23, v7
  s_waitcnt vmcnt(1)
  v_lshlrev_b32 v6, 16, v120
  v_and_b32 v7, 0xffff0000, v120
  v_add_f32 v16, v16, v6
  v_add_f32 v17, v17, v7
  v_lshlrev_b32 v6, 16, v121
  v_and_b32 v7, 0xffff0000, v121
  v_add_f32 v18, v18, v6
  v_add_f32 v19, v19, v7
  v_lshlrev_b32 v6, 16, v122
  v_and_b32 v7, 0xffff0000, v122
  v_add_f32 v20, v20, v6
  v_add_f32 v21, v21, v7
  v_lshlrev_b32 v6, 16, v123
  v_and_b32 v7, 0xffff0000, v123
  v_add_f32 v22, v22, v6
  v_add_f32 v23, v23, v7
  s_waitcnt vmcnt(0)
  v_lshlrev_b32 v6, 16, v124
  v_and_b32 v7, 0xffff0000, v124
  v_add_f32 v16, v16, v6
  v_add_f32 v17, v17, v7
  v_lshlrev_b32 v6, 16, v125
  v_and_b32 v7, 0xffff0000, v125
  v_add_f32 v18, v18, v6
  v_add_f32 v19, v19, v7
  v_lshlrev_b32 v6, 16, v126
  v_and_b32 v7, 0xffff0000, v126
  v_add_f32 v20, v20, v6
  v_add_f32 v21, v21, v7
  v_lshlrev_b32 v6, 16, v127
  v_and_b32 v7, 0xffff0000, v127
  v_add_f32 v22, v22, v6
  v_add_f32 v23, v23, v7
  v_lshrrev_b32 v6, 4, v0
  s_lshl_b32 s57, s48, 2
  v_add_u32 v6, s57, v6
  v_lshlrev_b32 v6, 9, v6
  v_lshl_add_u32 v6, v5, 5, v6
  ds_write_b128 v6, v[16:19]
  ds_write_b128 v6, v[20:23] offset:16
  s_waitcnt lgkmcnt(0)
  s_barrier
  s_cmp_ge_u32 s48, 2
  s_cbranch_scc1 K1H_WARM
  v_mov_b32 v13, 32768
  ds_read_b32 v13, v13
  s_waitcnt lgkmcnt(0)
  v_readfirstlane_b32 s98, v13
  s_lshl_b32 s57, s48, 6
  v_add_u32 v6, s57, v0
  v_lshlrev_b32 v7, 2, v6
  ds_read_b32 v128, v7 offset:0
  ds_read_b32 v129, v7 offset:512
  ds_read_b32 v130, v7 offset:1024
  ds_read_b32 v131, v7 offset:1536
  ds_read_b32 v132, v7 offset:2048
  ds_read_b32 v133, v7 offset:2560
  ds_read_b32 v134, v7 offset:3072
  ds_read_b32 v135, v7 offset:3584
  ds_read_b32 v136, v7 offset:4096
  ds_read_b32 v137, v7 offset:4608
  ds_read_b32 v138, v7 offset:5120
  ds_read_b32 v139, v7 offset:5632
  ds_read_b32 v140, v7 offset:6144
  ds_read_b32 v141, v7 offset:6656
  ds_read_b32 v142, v7 offset:7168
  ds_read_b32 v143, v7 offset:7680
  ds_read_b32 v144, v7 offset:8192
  ds_read_b32 v145, v7 offset:8704
  ds_read_b32 v146, v7 offset:9216
  ds_read_b32 v147, v7 offset:9728
  ds_read_b32 v148, v7 offset:10240
  ds_read_b32 v149, v7 offset:10752
  ds_read_b32 v150, v7 offset:11264
  ds_read_b32 v151, v7 offset:11776
  ds_read_b32 v152, v7 offset:12288
  ds_read_b32 v153, v7 offset:12800
  ds_read_b32 v154, v7 offset:13312
  ds_read_b32 v155, v7 offset:13824
  ds_read_b32 v156, v7 offset:14336
  ds_read_b32 v157, v7 offset:14848
  ds_read_b32 v158, v7 offset:15360
  ds_read_b32 v159, v7 offset:15872
  s_waitcnt lgkmcnt(0)
  v_add_f32 v128, v128, v144
  v_add_f32 v129, v129, v145
  v_add_f32 v130, v130, v146
  v_add_f32 v131, v131, v147
  v_add_f32 v132, v132, v148
  v_add_f32 v133, v133, v149
  v_add_f32 v134, v134, v150
  v_add_f32 v135, v135, v151
  v_add_f32 v136, v136, v152
  v_add_f32 v137, v137, v153
  v_add_f32 v138, v138, v154
  v_add_f32 v139, v139, v155
  v_add_f32 v140, v140, v156
  v_add_f32 v141, v141, v157
  v_add_f32 v142, v142, v158
  v_add_f32 v143, v143, v159
  v_add_f32 v128, v128, v136
  v_add_f32 v129, v129, v137
  v_add_f32 v130, v130, v138
  v_add_f32 v131, v131, v139
  v_add_f32 v132, v132, v140
  v_add_f32 v133, v133, v141
  v_add_f32 v134, v134, v142
  v_add_f32 v135, v135, v143
  v_add_f32 v128, v128, v132
  v_add_f32 v129, v129, v133
  v_add_f32 v130, v130, v134
  v_add_f32 v131, v131, v135
  v_add_f32 v128, v128, v130
  v_add_f32 v129, v129, v131
  v_add_f32 v128, v128, v129
  s_lshl_b32 s57, s54, 7
  s_add_u32 s57, s57, s56
  v_add_u32 v6, s57, v6
  v_lshlrev_b32 v6, 3, v6
  v_add_u32 v6, 11042816, v6
  v_mov_b32 v129, s98
  buffer_store_dwordx2 v[128:129], v6, s[32:35], 0 offen sc1
K1H_WARM:
  s_lshl_b32 s49, s2, 3
  s_add_u32 s49, s49, s48
  s_mul_i32 s50, s49, 49
  v_min_u32 v6, 48, v0
  v_add_u32 v6, s50, v6
  v_lshlrev_b32 v6, 7, v6
  global_load_dword v7, v6, s[86:87]
  s_mul_i32 s50, s49, 13
  v_and_b32 v6, 15, v0
  v_min_u32 v6, 12, v6
  v_add_u32 v6, s50, v6
  v_min_u32 v6, 3135, v6
  v_lshlrev_b32 v6, 7, v6
  global_load_dword v8, v6, s[88:89]
  global_load_dword v9, v6, s[90:91]
  s_waitcnt vmcnt(0)
K1_CODE_LAST:
  s_endpgm
.section .rodata,"a"
.p2align 6
.amdhsa_kernel recurrent_scan__ssm_conv_s5__glu_gated_glu__prompt_kernel
  .amdhsa_next_free_vgpr 256
  .amdhsa_next_free_sgpr 102
  .amdhsa_accum_offset 256
  .amdhsa_group_segment_fixed_size 0
  .amdhsa_kernarg_size 128
  .amdhsa_user_sgpr_count 2
  .amdhsa_user_sgpr_kernarg_segment_ptr 1
  .amdhsa_system_sgpr_workgroup_id_x 1
.end_amdhsa_kernel
```
